```python
import torch

def _softmax(x, axis=-1):
    return torch.softmax(x, dim=axis)
def _gelu(x):
    return torch.nn.functional.gelu(x, approximate="tanh")
def _silu(x):
    return torch.nn.functional.silu(x)
def _sigmoid(x):
    return torch.sigmoid(x)
def _layernorm(x, axis=-1, eps=1e-5):
    m = x.mean(dim=axis, keepdim=True)
    v = x.var(dim=axis, keepdim=True, unbiased=False)
    return (x - m) / torch.sqrt(v + eps)
def _scatter_add(tgt, idx, src, axis=0):
    return tgt.clone().index_add_(axis, idx, src)
def _segment_sum(src, seg, n):
    out = torch.zeros((n,) + src.shape[1:], dtype=src.dtype)
    return out.index_add_(0, seg, src)
def _pad(x, pw):
    flat = tuple(v for pair in reversed(pw) for v in pair)
    return torch.nn.functional.pad(x, flat)

kernel_name = 'parallel_sum__sliding_block_cached__glu_gated_glu__decode'

def setup_inputs():

    _w = (lambda a: (lambda t: t.to(torch.bfloat16) if t.is_floating_point() else t)(torch.as_tensor(a)))
    def _A_setup():
        B, Sq, D = 1, 1, 448
        Hq, Hkv, Sk, Dh = 16, 8, 65536, 256
        assert Hq % Hkv == 0, (Hq, Hkv)
        return {
            "x": _w((lambda *s: torch.randn(*s, dtype=torch.bfloat16) * 0.05)(B, Sq, D)),
            "k_cache": _w((lambda *s: torch.randn(*s, dtype=torch.bfloat16) * 3.2)(B, Hkv, Sk, Dh)),
            "v_cache": _w((lambda *s: torch.randn(*s, dtype=torch.bfloat16) * 1.6)(B, Hkv, Sk, Dh)),
            "wq": _w((lambda *s: torch.randn(*s, dtype=torch.bfloat16) * 3.2)(D, Hq * Dh) * (D ** -0.5)),
            "wo": _w((lambda *s: torch.randn(*s, dtype=torch.bfloat16) * 1.6)(Hq * Dh, D) * ((Hq * Dh) ** -0.5)),
        }
    _A_in = _A_setup()

    def _B_setup():
        B, S, D, F = 1, 1, 448, 1792
        return {
            "x": _w((lambda *s: torch.randn(*s, dtype=torch.bfloat16) * 0.05)(B, S, D)),
            "w_gate": _w((lambda *s: torch.randn(*s, dtype=torch.bfloat16) * 0.1)(D, F)),
            "w_up": _w((lambda *s: torch.randn(*s, dtype=torch.bfloat16) * 0.05)(D, F)),
            "w_down": _w((lambda *s: torch.randn(*s, dtype=torch.bfloat16) * 0.05)(F, D)),
        }
    _B_in = _B_setup()

    return {
        "A_x": _A_in["x"],
        "A_k_cache": _A_in["k_cache"],
        "A_v_cache": _A_in["v_cache"],
        "A_wq": _A_in["wq"],
        "A_wo": _A_in["wo"],
        "B_x": _B_in["x"],
        "B_w_gate": _B_in["w_gate"],
        "B_w_up": _B_in["w_up"],
        "B_w_down": _B_in["w_down"],
    }

def reference(A_x, A_k_cache, A_v_cache, A_wq, A_wo, B_x, B_w_gate, B_w_up, B_w_down):
    def _A_ref(x, k_cache, v_cache, wq, wo):
        B, Sq, D = x.shape
        Hq, Dh = 16, 256
        Hkv, Sk = k_cache.shape[1], k_cache.shape[2]
        W = min(4096, max(256, Sk // 4))
        rep = Hq // Hkv
        q = (lambda x, *d: x.permute(*d))((x @ wq).reshape(B, Sq, Hq, Dh), 0, 2, 1, 3)
        k = (lambda x, n, axis: torch.repeat_interleave(x, n, dim=axis))(k_cache[:, :, Sk - W:, :], rep, axis=1)
        v = (lambda x, n, axis: torch.repeat_interleave(x, n, dim=axis))(v_cache[:, :, Sk - W:, :], rep, axis=1)
        scores = torch.einsum("bhqd,bhkd->bhqk", q, k) * (Dh ** -0.5)
        p = _softmax(scores, axis=-1)
        o = torch.einsum("bhqk,bhkd->bhqd", p, v)
        return (lambda x, *d: x.permute(*d))(o, 0, 2, 1, 3).reshape(B, Sq, Hq * Dh) @ wo

    def _B_ref(x, w_gate, w_up, w_down):
        g = torch.einsum("bsd,df->bsf", x, w_gate)
        u = torch.einsum("bsd,df->bsf", x, w_up)
        h = _sigmoid(g) * u
        return torch.einsum("bsf,fd->bsd", h, w_down)

    x = A_x
    xn = _layernorm(x, axis=-1)
    return x + _A_ref(xn, A_k_cache, A_v_cache, A_wq, A_wo) + _B_ref(xn, B_w_gate, B_w_up, B_w_down)
```

```asm
; @launch kernel=proj_kernel grid=(240,1,1) block=(256,1,1) lds=8192
; @launch kernel=attn_kernel grid=(256,1,1) block=(512,1,1) lds=69632
; @launch kernel=outp_kernel grid=(256,1,1) block=(512,1,1) lds=32768
; @launch kernel=final_kernel grid=(7,1,1) block=(64,1,1) lds=0
.amdgcn_target "amdgcn-amd-amdhsa--gfx950"
.text
.globl proj_kernel
.p2align 8
.type proj_kernel,@function
proj_kernel:
    s_load_dwordx2 s[4:5], s[0:1], 0
    s_load_dwordx2 s[6:7], s[0:1], 24
    s_load_dwordx2 s[8:9], s[0:1], 48
    s_load_dwordx2 s[10:11], s[0:1], 56
    s_load_dwordx2 s[12:13], s[0:1], 88
    v_lshrrev_b32 v1, 6, v0
    v_and_b32 v2, 63, v0
    s_nop 0
    v_readfirstlane_b32 s14, v1
    s_cmp_ge_u32 s2, 240
    s_cbranch_scc1 proj_end
    s_lshl_b32 s15, s2, 2
    s_add_u32 s15, s15, s14
    s_lshr_b32 s16, s15, 3
    s_and_b32 s17, s15, 7
    s_waitcnt lgkmcnt(0)
    s_cmp_lt_u32 s16, 64
    s_cbranch_scc0 proj_notq
    s_mov_b32 s18, s6
    s_mov_b32 s19, s7
    s_mov_b32 s20, 8192
    s_lshl_b32 s21, s16, 7
    s_lshl_b32 s22, s17, 14
    s_lshl_b32 s24, s16, 8
    s_add_u32 s22, s22, s24
    s_add_u32 s22, s22, 0
    s_mov_b32 s23, 3670016
    s_branch proj_sel_done
proj_notq:
    s_mov_b32 s20, 3584
    s_mov_b32 s23, 1605632
    s_sub_u32 s24, s16, 64
    s_mul_i32 s22, s17, 14336
    s_lshl_b32 s25, s24, 8
    s_add_u32 s22, s22, s25
    s_add_u32 s22, s22, 131072
    s_cmp_lt_u32 s16, 92
    s_cbranch_scc0 proj_up
    s_mov_b32 s18, s8
    s_mov_b32 s19, s9
    s_lshl_b32 s21, s24, 7
    s_branch proj_sel_done
proj_up:
    s_mov_b32 s18, s10
    s_mov_b32 s19, s11
    s_sub_u32 s25, s16, 92
    s_lshl_b32 s21, s25, 7
proj_sel_done:
    s_mov_b32 s28, s18
    s_mov_b32 s29, s19
    s_mov_b32 s30, s23
    s_mov_b32 s31, 0x00020000
    s_mov_b32 s32, s4
    s_mov_b32 s33, s5
    s_mov_b32 s34, 896
    s_mov_b32 s35, 0x00020000
    s_mov_b32 s36, s12
    s_mov_b32 s37, s13
    s_mov_b32 s38, 1073741824
    s_mov_b32 s39, 0x00020000
    v_lshlrev_b32 v3, 1, v2
    buffer_load_ushort v10, v3, s[32:35], 0 offen offset:0
    buffer_load_ushort v11, v3, s[32:35], 0 offen offset:128
    buffer_load_ushort v12, v3, s[32:35], 0 offen offset:256
    buffer_load_ushort v13, v3, s[32:35], 0 offen offset:384
    buffer_load_ushort v14, v3, s[32:35], 0 offen offset:512
    buffer_load_ushort v15, v3, s[32:35], 0 offen offset:640
    buffer_load_ushort v16, v3, s[32:35], 0 offen offset:768
    v_lshrrev_b32 v4, 3, v2
    s_mul_i32 s24, s17, 56
    v_add_u32 v5, s24, v4
    v_lshlrev_b32 v5, 1, v5
    buffer_load_ushort v20, v5, s[32:35], 0 offen offset:0
    buffer_load_ushort v21, v5, s[32:35], 0 offen offset:16
    buffer_load_ushort v22, v5, s[32:35], 0 offen offset:32
    buffer_load_ushort v23, v5, s[32:35], 0 offen offset:48
    buffer_load_ushort v24, v5, s[32:35], 0 offen offset:64
    buffer_load_ushort v25, v5, s[32:35], 0 offen offset:80
    buffer_load_ushort v26, v5, s[32:35], 0 offen offset:96
    v_mul_lo_u32 v6, v4, s20
    v_and_b32 v7, 7, v2
    v_lshlrev_b32 v7, 4, v7
    v_add_u32 v6, v6, v7
    s_mul_i32 s24, s24, s20
    s_add_u32 s24, s24, s21
    s_lshl_b32 s25, s20, 3
    buffer_load_dwordx4 v[32:35], v6, s[28:31], s24 offen
    s_add_u32 s24, s24, s25
    buffer_load_dwordx4 v[36:39], v6, s[28:31], s24 offen
    s_add_u32 s24, s24, s25
    buffer_load_dwordx4 v[40:43], v6, s[28:31], s24 offen
    s_add_u32 s24, s24, s25
    buffer_load_dwordx4 v[44:47], v6, s[28:31], s24 offen
    s_add_u32 s24, s24, s25
    buffer_load_dwordx4 v[48:51], v6, s[28:31], s24 offen
    s_add_u32 s24, s24, s25
    buffer_load_dwordx4 v[52:55], v6, s[28:31], s24 offen
    s_add_u32 s24, s24, s25
    buffer_load_dwordx4 v[56:59], v6, s[28:31], s24 offen
    s_waitcnt vmcnt(14)
    v_lshlrev_b32 v10, 16, v10
    v_lshlrev_b32 v11, 16, v11
    v_lshlrev_b32 v12, 16, v12
    v_lshlrev_b32 v13, 16, v13
    v_lshlrev_b32 v14, 16, v14
    v_lshlrev_b32 v15, 16, v15
    v_lshlrev_b32 v16, 16, v16
    v_add_f32 v8, v10, v11
    v_add_f32 v8, v8, v12
    v_add_f32 v8, v8, v13
    v_add_f32 v8, v8, v14
    v_add_f32 v8, v8, v15
    v_add_f32 v8, v8, v16
    s_nop 1
    v_add_f32_dpp v8, v8, v8 quad_perm:[1,0,3,2] row_mask:0xf bank_mask:0xf
    s_nop 1
    v_add_f32_dpp v8, v8, v8 quad_perm:[2,3,0,1] row_mask:0xf bank_mask:0xf
    s_nop 1
    v_add_f32_dpp v8, v8, v8 row_half_mirror row_mask:0xf bank_mask:0xf
    s_nop 1
    v_add_f32_dpp v8, v8, v8 row_mirror row_mask:0xf bank_mask:0xf
    s_nop 1
    v_readlane_b32 s40, v8, 0
    v_readlane_b32 s41, v8, 16
    v_readlane_b32 s42, v8, 32
    v_readlane_b32 s43, v8, 48
    s_nop 1
    v_mov_b32 v8, s40
    v_add_f32 v8, s41, v8
    v_add_f32 v8, s42, v8
    v_add_f32 v8, s43, v8
    v_mul_f32 v8, 0x3b124925, v8
    v_sub_f32 v9, v10, v8
    v_mul_f32 v9, v9, v9
    v_sub_f32 v17, v11, v8
    v_fmac_f32 v9, v17, v17
    v_sub_f32 v17, v12, v8
    v_fmac_f32 v9, v17, v17
    v_sub_f32 v17, v13, v8
    v_fmac_f32 v9, v17, v17
    v_sub_f32 v17, v14, v8
    v_fmac_f32 v9, v17, v17
    v_sub_f32 v17, v15, v8
    v_fmac_f32 v9, v17, v17
    v_sub_f32 v17, v16, v8
    v_fmac_f32 v9, v17, v17
    s_nop 1
    v_add_f32_dpp v9, v9, v9 quad_perm:[1,0,3,2] row_mask:0xf bank_mask:0xf
    s_nop 1
    v_add_f32_dpp v9, v9, v9 quad_perm:[2,3,0,1] row_mask:0xf bank_mask:0xf
    s_nop 1
    v_add_f32_dpp v9, v9, v9 row_half_mirror row_mask:0xf bank_mask:0xf
    s_nop 1
    v_add_f32_dpp v9, v9, v9 row_mirror row_mask:0xf bank_mask:0xf
    s_nop 1
    v_readlane_b32 s40, v9, 0
    v_readlane_b32 s41, v9, 16
    v_readlane_b32 s42, v9, 32
    v_readlane_b32 s43, v9, 48
    s_nop 1
    v_mov_b32 v9, s40
    v_add_f32 v9, s41, v9
    v_add_f32 v9, s42, v9
    v_add_f32 v9, s43, v9
    v_mul_f32 v9, 0x3b124925, v9
    v_cvt_pk_bf16_f32 v8, v8, v8
    v_lshlrev_b32 v8, 16, v8
    v_cvt_pk_bf16_f32 v9, v9, v9
    v_lshlrev_b32 v9, 16, v9
    v_add_f32 v9, 0x3727c5ac, v9
    v_cvt_pk_bf16_f32 v9, v9, v9
    v_lshlrev_b32 v9, 16, v9
    v_sqrt_f32 v9, v9
    s_nop 0
    v_cvt_pk_bf16_f32 v9, v9, v9
    v_lshlrev_b32 v9, 16, v9
    v_rcp_f32 v9, v9
    s_waitcnt vmcnt(7)
    v_lshlrev_b32 v20, 16, v20
    v_sub_f32 v20, v20, v8
    v_cvt_pk_bf16_f32 v20, v20, v20
    v_lshlrev_b32 v20, 16, v20
    v_mul_f32 v20, v20, v9
    v_cvt_pk_bf16_f32 v20, v20, v20
    v_lshlrev_b32 v20, 16, v20
    v_lshlrev_b32 v21, 16, v21
    v_sub_f32 v21, v21, v8
    v_cvt_pk_bf16_f32 v21, v21, v21
    v_lshlrev_b32 v21, 16, v21
    v_mul_f32 v21, v21, v9
    v_cvt_pk_bf16_f32 v21, v21, v21
    v_lshlrev_b32 v21, 16, v21
    v_lshlrev_b32 v22, 16, v22
    v_sub_f32 v22, v22, v8
    v_cvt_pk_bf16_f32 v22, v22, v22
    v_lshlrev_b32 v22, 16, v22
    v_mul_f32 v22, v22, v9
    v_cvt_pk_bf16_f32 v22, v22, v22
    v_lshlrev_b32 v22, 16, v22
    v_lshlrev_b32 v23, 16, v23
    v_sub_f32 v23, v23, v8
    v_cvt_pk_bf16_f32 v23, v23, v23
    v_lshlrev_b32 v23, 16, v23
    v_mul_f32 v23, v23, v9
    v_cvt_pk_bf16_f32 v23, v23, v23
    v_lshlrev_b32 v23, 16, v23
    v_lshlrev_b32 v24, 16, v24
    v_sub_f32 v24, v24, v8
    v_cvt_pk_bf16_f32 v24, v24, v24
    v_lshlrev_b32 v24, 16, v24
    v_mul_f32 v24, v24, v9
    v_cvt_pk_bf16_f32 v24, v24, v24
    v_lshlrev_b32 v24, 16, v24
    v_lshlrev_b32 v25, 16, v25
    v_sub_f32 v25, v25, v8
    v_cvt_pk_bf16_f32 v25, v25, v25
    v_lshlrev_b32 v25, 16, v25
    v_mul_f32 v25, v25, v9
    v_cvt_pk_bf16_f32 v25, v25, v25
    v_lshlrev_b32 v25, 16, v25
    v_lshlrev_b32 v26, 16, v26
    v_sub_f32 v26, v26, v8
    v_cvt_pk_bf16_f32 v26, v26, v26
    v_lshlrev_b32 v26, 16, v26
    v_mul_f32 v26, v26, v9
    v_cvt_pk_bf16_f32 v26, v26, v26
    v_lshlrev_b32 v26, 16, v26
    v_mov_b32 v64, 0
    v_mov_b32 v65, 0
    v_mov_b32 v66, 0
    v_mov_b32 v67, 0
    v_mov_b32 v68, 0
    v_mov_b32 v69, 0
    v_mov_b32 v70, 0
    v_mov_b32 v71, 0
    s_waitcnt vmcnt(6)
    v_lshlrev_b32 v72, 16, v32
    v_and_b32 v73, 0xffff0000, v32
    v_fmac_f32 v64, v72, v20
    v_fmac_f32 v65, v73, v20
    v_lshlrev_b32 v72, 16, v33
    v_and_b32 v73, 0xffff0000, v33
    v_fmac_f32 v66, v72, v20
    v_fmac_f32 v67, v73, v20
    v_lshlrev_b32 v72, 16, v34
    v_and_b32 v73, 0xffff0000, v34
    v_fmac_f32 v68, v72, v20
    v_fmac_f32 v69, v73, v20
    v_lshlrev_b32 v72, 16, v35
    v_and_b32 v73, 0xffff0000, v35
    v_fmac_f32 v70, v72, v20
    v_fmac_f32 v71, v73, v20
    s_waitcnt vmcnt(5)
    v_lshlrev_b32 v72, 16, v36
    v_and_b32 v73, 0xffff0000, v36
    v_fmac_f32 v64, v72, v21
    v_fmac_f32 v65, v73, v21
    v_lshlrev_b32 v72, 16, v37
    v_and_b32 v73, 0xffff0000, v37
    v_fmac_f32 v66, v72, v21
    v_fmac_f32 v67, v73, v21
    v_lshlrev_b32 v72, 16, v38
    v_and_b32 v73, 0xffff0000, v38
    v_fmac_f32 v68, v72, v21
    v_fmac_f32 v69, v73, v21
    v_lshlrev_b32 v72, 16, v39
    v_and_b32 v73, 0xffff0000, v39
    v_fmac_f32 v70, v72, v21
    v_fmac_f32 v71, v73, v21
    s_waitcnt vmcnt(4)
    v_lshlrev_b32 v72, 16, v40
    v_and_b32 v73, 0xffff0000, v40
    v_fmac_f32 v64, v72, v22
    v_fmac_f32 v65, v73, v22
    v_lshlrev_b32 v72, 16, v41
    v_and_b32 v73, 0xffff0000, v41
    v_fmac_f32 v66, v72, v22
    v_fmac_f32 v67, v73, v22
    v_lshlrev_b32 v72, 16, v42
    v_and_b32 v73, 0xffff0000, v42
    v_fmac_f32 v68, v72, v22
    v_fmac_f32 v69, v73, v22
    v_lshlrev_b32 v72, 16, v43
    v_and_b32 v73, 0xffff0000, v43
    v_fmac_f32 v70, v72, v22
    v_fmac_f32 v71, v73, v22
    s_waitcnt vmcnt(3)
    v_lshlrev_b32 v72, 16, v44
    v_and_b32 v73, 0xffff0000, v44
    v_fmac_f32 v64, v72, v23
    v_fmac_f32 v65, v73, v23
    v_lshlrev_b32 v72, 16, v45
    v_and_b32 v73, 0xffff0000, v45
    v_fmac_f32 v66, v72, v23
    v_fmac_f32 v67, v73, v23
    v_lshlrev_b32 v72, 16, v46
    v_and_b32 v73, 0xffff0000, v46
    v_fmac_f32 v68, v72, v23
    v_fmac_f32 v69, v73, v23
    v_lshlrev_b32 v72, 16, v47
    v_and_b32 v73, 0xffff0000, v47
    v_fmac_f32 v70, v72, v23
    v_fmac_f32 v71, v73, v23
    s_waitcnt vmcnt(2)
    v_lshlrev_b32 v72, 16, v48
    v_and_b32 v73, 0xffff0000, v48
    v_fmac_f32 v64, v72, v24
    v_fmac_f32 v65, v73, v24
    v_lshlrev_b32 v72, 16, v49
    v_and_b32 v73, 0xffff0000, v49
    v_fmac_f32 v66, v72, v24
    v_fmac_f32 v67, v73, v24
    v_lshlrev_b32 v72, 16, v50
    v_and_b32 v73, 0xffff0000, v50
    v_fmac_f32 v68, v72, v24
    v_fmac_f32 v69, v73, v24
    v_lshlrev_b32 v72, 16, v51
    v_and_b32 v73, 0xffff0000, v51
    v_fmac_f32 v70, v72, v24
    v_fmac_f32 v71, v73, v24
    s_waitcnt vmcnt(1)
    v_lshlrev_b32 v72, 16, v52
    v_and_b32 v73, 0xffff0000, v52
    v_fmac_f32 v64, v72, v25
    v_fmac_f32 v65, v73, v25
    v_lshlrev_b32 v72, 16, v53
    v_and_b32 v73, 0xffff0000, v53
    v_fmac_f32 v66, v72, v25
    v_fmac_f32 v67, v73, v25
    v_lshlrev_b32 v72, 16, v54
    v_and_b32 v73, 0xffff0000, v54
    v_fmac_f32 v68, v72, v25
    v_fmac_f32 v69, v73, v25
    v_lshlrev_b32 v72, 16, v55
    v_and_b32 v73, 0xffff0000, v55
    v_fmac_f32 v70, v72, v25
    v_fmac_f32 v71, v73, v25
    s_waitcnt vmcnt(0)
    v_lshlrev_b32 v72, 16, v56
    v_and_b32 v73, 0xffff0000, v56
    v_fmac_f32 v64, v72, v26
    v_fmac_f32 v65, v73, v26
    v_lshlrev_b32 v72, 16, v57
    v_and_b32 v73, 0xffff0000, v57
    v_fmac_f32 v66, v72, v26
    v_fmac_f32 v67, v73, v26
    v_lshlrev_b32 v72, 16, v58
    v_and_b32 v73, 0xffff0000, v58
    v_fmac_f32 v68, v72, v26
    v_fmac_f32 v69, v73, v26
    v_lshlrev_b32 v72, 16, v59
    v_and_b32 v73, 0xffff0000, v59
    v_fmac_f32 v70, v72, v26
    v_fmac_f32 v71, v73, v26
    s_lshl_b32 s24, s14, 11
    v_lshlrev_b32 v74, 8, v4
    v_lshlrev_b32 v75, 1, v7
    v_add3_u32 v74, v74, v75, s24
    ds_write_b128 v74, v[64:67]
    ds_write_b128 v74, v[68:71] offset:16
    v_lshlrev_b32 v76, 2, v2
    v_add_u32 v77, s24, v76
    s_waitcnt lgkmcnt(0)
    ds_read_b32 v80, v77 offset:0
    ds_read_b32 v81, v77 offset:256
    ds_read_b32 v82, v77 offset:512
    ds_read_b32 v83, v77 offset:768
    ds_read_b32 v84, v77 offset:1024
    ds_read_b32 v85, v77 offset:1280
    ds_read_b32 v86, v77 offset:1536
    ds_read_b32 v87, v77 offset:1792
    s_waitcnt lgkmcnt(0)
    v_add_f32 v80, v80, v81
    v_add_f32 v80, v80, v82
    v_add_f32 v80, v80, v83
    v_add_f32 v80, v80, v84
    v_add_f32 v80, v80, v85
    v_add_f32 v80, v80, v86
    v_add_f32 v80, v80, v87
    buffer_store_dword v80, v76, s[36:39], s22 offen
proj_end:
    s_endpgm
.globl attn_kernel
.p2align 8
.type attn_kernel,@function
attn_kernel:
    s_load_dwordx4 s[4:7], s[0:1], 8
    s_load_dwordx2 s[12:13], s[0:1], 88
    v_lshrrev_b32 v1, 6, v0
    v_and_b32 v2, 63, v0
    s_nop 0
    v_readfirstlane_b32 s14, v1
    s_cmp_ge_u32 s2, 256
    s_cbranch_scc1 attn_end
    s_lshr_b32 s15, s2, 5
    s_and_b32 s16, s2, 31
    s_waitcnt lgkmcnt(0)
    s_lshl_b32 s17, s15, 25
    s_lshl_b32 s18, s16, 16
    s_add_u32 s17, s17, s18
    s_add_u32 s17, s17, 31457280
    s_add_u32 s4, s4, s17
    s_addc_u32 s5, s5, 0
    s_add_u32 s6, s6, s17
    s_addc_u32 s7, s7, 0
    s_mov_b32 s20, s4
    s_mov_b32 s21, s5
    s_mov_b32 s22, 65536
    s_mov_b32 s23, 0x00020000
    s_mov_b32 s24, s6
    s_mov_b32 s25, s7
    s_mov_b32 s26, 65536
    s_mov_b32 s27, 0x00020000
    s_mov_b32 s36, s12
    s_mov_b32 s37, s13
    s_mov_b32 s38, 1073741824
    s_mov_b32 s39, 0x00020000
    v_and_b32 v3, 15, v2
    v_lshrrev_b32 v4, 4, v2
    s_lshl_b32 s18, s14, 13
    v_lshlrev_b32 v5, 9, v3
    v_lshlrev_b32 v6, 4, v4
    v_add3_u32 v5, v5, v6, s18
    buffer_load_dwordx4 v[32:35], v5, s[20:23], 0 offen offset:0
    buffer_load_dwordx4 v[36:39], v5, s[20:23], 0 offen offset:64
    buffer_load_dwordx4 v[40:43], v5, s[20:23], 0 offen offset:128
    buffer_load_dwordx4 v[44:47], v5, s[20:23], 0 offen offset:192
    buffer_load_dwordx4 v[48:51], v5, s[20:23], 0 offen offset:256
    buffer_load_dwordx4 v[52:55], v5, s[20:23], 0 offen offset:320
    buffer_load_dwordx4 v[56:59], v5, s[20:23], 0 offen offset:384
    buffer_load_dwordx4 v[60:63], v5, s[20:23], 0 offen offset:448
    v_lshlrev_b32 v7, 4, v2
    v_add_u32 v7, s18, v7
    s_add_u32 s19, s18, 4096
    s_mov_b32 m0, s19
    s_nop 0
    buffer_load_dwordx4 v7, s[24:27], 0 offen offset:0 lds
    buffer_load_dwordx4 v7, s[24:27], 0 offen offset:1024 lds
    buffer_load_dwordx4 v7, s[24:27], 0 offen offset:2048 lds
    buffer_load_dwordx4 v7, s[24:27], 0 offen offset:3072 lds
    s_add_u32 s19, s18, 8192
    s_mov_b32 m0, s19
    v_add_u32 v7, 4096, v7
    buffer_load_dwordx4 v7, s[24:27], 0 offen offset:0 lds
    buffer_load_dwordx4 v7, s[24:27], 0 offen offset:1024 lds
    buffer_load_dwordx4 v7, s[24:27], 0 offen offset:2048 lds
    buffer_load_dwordx4 v7, s[24:27], 0 offen offset:3072 lds
    s_lshl_b32 s19, s15, 11
    v_lshlrev_b32 v8, 2, v0
    v_add_u32 v8, s19, v8
    s_mov_b32 s40, 0
    buffer_load_dword v10, v8, s[36:39], s40 offen
    s_mov_b32 s40, 16384
    buffer_load_dword v11, v8, s[36:39], s40 offen
    s_mov_b32 s40, 32768
    buffer_load_dword v12, v8, s[36:39], s40 offen
    s_mov_b32 s40, 49152
    buffer_load_dword v13, v8, s[36:39], s40 offen
    s_mov_b32 s40, 65536
    buffer_load_dword v14, v8, s[36:39], s40 offen
    s_mov_b32 s40, 81920
    buffer_load_dword v15, v8, s[36:39], s40 offen
    s_mov_b32 s40, 98304
    buffer_load_dword v16, v8, s[36:39], s40 offen
    s_mov_b32 s40, 114688
    buffer_load_dword v17, v8, s[36:39], s40 offen
    s_waitcnt vmcnt(0)
    v_add_f32 v10, v10, v11
    v_add_f32 v10, v10, v12
    v_add_f32 v10, v10, v13
    v_add_f32 v10, v10, v14
    v_add_f32 v10, v10, v15
    v_add_f32 v10, v10, v16
    v_add_f32 v10, v10, v17
    v_cvt_pk_bf16_f32 v10, v10, v10
    v_lshlrev_b32 v9, 1, v0
    ds_write_b16 v9, v10 offset:0
    s_waitcnt lgkmcnt(0)
    s_barrier
    v_and_b32 v9, 1, v2
    v_lshlrev_b32 v9, 9, v9
    v_add_u32 v9, v9, v6
    ds_read_b128 v[64:67], v9 offset:0
    ds_read_b128 v[68:71], v9 offset:64
    ds_read_b128 v[72:75], v9 offset:128
    ds_read_b128 v[76:79], v9 offset:192
    ds_read_b128 v[80:83], v9 offset:256
    ds_read_b128 v[84:87], v9 offset:320
    ds_read_b128 v[88:91], v9 offset:384
    ds_read_b128 v[92:95], v9 offset:448
    v_mov_b32 v96, 0
    v_mov_b32 v97, 0
    v_mov_b32 v98, 0
    v_mov_b32 v99, 0
    s_waitcnt lgkmcnt(0)
    s_nop 1
    v_mfma_f32_16x16x32_bf16 v[96:99], v[64:67], v[32:35], v[96:99]
    v_mfma_f32_16x16x32_bf16 v[96:99], v[68:71], v[36:39], v[96:99]
    v_mfma_f32_16x16x32_bf16 v[96:99], v[72:75], v[40:43], v[96:99]
    v_mfma_f32_16x16x32_bf16 v[96:99], v[76:79], v[44:47], v[96:99]
    v_mfma_f32_16x16x32_bf16 v[96:99], v[80:83], v[48:51], v[96:99]
    v_mfma_f32_16x16x32_bf16 v[96:99], v[84:87], v[52:55], v[96:99]
    v_mfma_f32_16x16x32_bf16 v[96:99], v[88:91], v[56:59], v[96:99]
    v_mfma_f32_16x16x32_bf16 v[96:99], v[92:95], v[60:63], v[96:99]
    s_nop 7
    s_nop 1
    v_cvt_pk_bf16_f32 v96, v96, v96
    v_lshlrev_b32 v96, 16, v96
    v_cvt_pk_bf16_f32 v97, v97, v97
    v_lshlrev_b32 v97, 16, v97
    v_mul_f32 v96, 0x3d800000, v96
    v_mul_f32 v97, 0x3d800000, v97
    s_lshl_b32 s19, s14, 6
    v_lshlrev_b32 v9, 2, v2
    v_add_u32 v9, s19, v9
    s_mov_b64 exec, 0xffff
    ds_write_b32 v9, v96 offset:1024
    ds_write_b32 v9, v97 offset:1536
    s_mov_b64 exec, -1
    s_waitcnt vmcnt(0) lgkmcnt(0)
    s_barrier
    v_lshlrev_b32 v9, 3, v2
    ds_read_b64 v[10:11], v9 offset:1024
    ds_read_b64 v[12:13], v9 offset:1536
    s_waitcnt lgkmcnt(0)
    v_max_f32 v14, v10, v11
    v_max_f32 v15, v12, v13
    s_nop 1
    v_max_f32_dpp v14, v14, v14 quad_perm:[1,0,3,2] row_mask:0xf bank_mask:0xf
    s_nop 1
    v_max_f32_dpp v14, v14, v14 quad_perm:[2,3,0,1] row_mask:0xf bank_mask:0xf
    s_nop 1
    v_max_f32_dpp v14, v14, v14 row_half_mirror row_mask:0xf bank_mask:0xf
    s_nop 1
    v_max_f32_dpp v14, v14, v14 row_mirror row_mask:0xf bank_mask:0xf
    s_nop 1
    v_readlane_b32 s40, v14, 0
    v_readlane_b32 s41, v14, 16
    v_readlane_b32 s42, v14, 32
    v_readlane_b32 s43, v14, 48
    s_nop 1
    v_mov_b32 v14, s40
    v_max_f32 v14, s41, v14
    v_max_f32 v14, s42, v14
    v_max_f32 v14, s43, v14
    s_nop 1
    v_max_f32_dpp v15, v15, v15 quad_perm:[1,0,3,2] row_mask:0xf bank_mask:0xf
    s_nop 1
    v_max_f32_dpp v15, v15, v15 quad_perm:[2,3,0,1] row_mask:0xf bank_mask:0xf
    s_nop 1
    v_max_f32_dpp v15, v15, v15 row_half_mirror row_mask:0xf bank_mask:0xf
    s_nop 1
    v_max_f32_dpp v15, v15, v15 row_mirror row_mask:0xf bank_mask:0xf
    s_nop 1
    v_readlane_b32 s40, v15, 0
    v_readlane_b32 s41, v15, 16
    v_readlane_b32 s42, v15, 32
    v_readlane_b32 s43, v15, 48
    s_nop 1
    v_mov_b32 v15, s40
    v_max_f32 v15, s41, v15
    v_max_f32 v15, s42, v15
    v_max_f32 v15, s43, v15
    v_sub_f32 v10, v10, v14
    v_mul_f32 v10, 0x3fb8aa3b, v10
    v_exp_f32 v10, v10
    v_sub_f32 v11, v11, v14
    v_mul_f32 v11, 0x3fb8aa3b, v11
    v_exp_f32 v11, v11
    v_sub_f32 v12, v12, v15
    v_mul_f32 v12, 0x3fb8aa3b, v12
    v_exp_f32 v12, v12
    v_sub_f32 v13, v13, v15
    v_mul_f32 v13, 0x3fb8aa3b, v13
    v_exp_f32 v13, v13
    s_nop 0
    v_add_f32 v16, v10, v11
    v_add_f32 v17, v12, v13
    s_nop 1
    v_add_f32_dpp v16, v16, v16 quad_perm:[1,0,3,2] row_mask:0xf bank_mask:0xf
    s_nop 1
    v_add_f32_dpp v16, v16, v16 quad_perm:[2,3,0,1] row_mask:0xf bank_mask:0xf
    s_nop 1
    v_add_f32_dpp v16, v16, v16 row_half_mirror row_mask:0xf bank_mask:0xf
    s_nop 1
    v_add_f32_dpp v16, v16, v16 row_mirror row_mask:0xf bank_mask:0xf
    s_nop 1
    v_readlane_b32 s40, v16, 0
    v_readlane_b32 s41, v16, 16
    v_readlane_b32 s42, v16, 32
    v_readlane_b32 s43, v16, 48
    s_nop 1
    v_mov_b32 v16, s40
    v_add_f32 v16, s41, v16
    v_add_f32 v16, s42, v16
    v_add_f32 v16, s43, v16
    s_nop 1
    v_add_f32_dpp v17, v17, v17 quad_perm:[1,0,3,2] row_mask:0xf bank_mask:0xf
    s_nop 1
    v_add_f32_dpp v17, v17, v17 quad_perm:[2,3,0,1] row_mask:0xf bank_mask:0xf
    s_nop 1
    v_add_f32_dpp v17, v17, v17 row_half_mirror row_mask:0xf bank_mask:0xf
    s_nop 1
    v_add_f32_dpp v17, v17, v17 row_mirror row_mask:0xf bank_mask:0xf
    s_nop 1
    v_readlane_b32 s40, v17, 0
    v_readlane_b32 s41, v17, 16
    v_readlane_b32 s42, v17, 32
    v_readlane_b32 s43, v17, 48
    s_nop 1
    v_mov_b32 v17, s40
    v_add_f32 v17, s41, v17
    v_add_f32 v17, s42, v17
    v_add_f32 v17, s43, v17
    v_cvt_pk_bf16_f32 v18, v10, v11
    v_cvt_pk_bf16_f32 v19, v12, v13
    v_lshlrev_b32 v9, 2, v2
    ds_write_b32 v9, v18 offset:2048
    ds_write_b32 v9, v19 offset:2304
    s_waitcnt lgkmcnt(0)
    v_and_b32 v9, 1, v2
    v_lshlrev_b32 v9, 8, v9
    v_add_u32 v9, v9, v6
    ds_read_b128 v[64:67], v9 offset:2048
    ds_read_b128 v[68:71], v9 offset:2112
    ds_read_b128 v[72:75], v9 offset:2176
    ds_read_b128 v[76:79], v9 offset:2240
    v_lshlrev_b32 v20, 12, v4
    v_lshrrev_b32 v21, 2, v3
    v_lshlrev_b32 v21, 9, v21
    v_and_b32 v22, 3, v3
    v_lshlrev_b32 v22, 3, v22
    v_add3_u32 v20, v20, v21, v22
    s_lshl_b32 s19, s14, 6
    v_add_u32 v20, s19, v20
    v_mov_b32 v100, 0
    v_mov_b32 v101, 0
    v_mov_b32 v102, 0
    v_mov_b32 v103, 0
    ds_read_b64_tr_b16 v[80:81], v20 offset:4096
    ds_read_b64_tr_b16 v[82:83], v20 offset:6144
    ds_read_b64_tr_b16 v[84:85], v20 offset:20480
    ds_read_b64_tr_b16 v[86:87], v20 offset:22528
    ds_read_b64_tr_b16 v[88:89], v20 offset:36864
    ds_read_b64_tr_b16 v[90:91], v20 offset:38912
    ds_read_b64_tr_b16 v[92:93], v20 offset:53248
    ds_read_b64_tr_b16 v[94:95], v20 offset:55296
    s_waitcnt lgkmcnt(0)
    v_mfma_f32_16x16x32_bf16 v[100:103], v[64:67], v[80:83], v[100:103]
    v_mfma_f32_16x16x32_bf16 v[100:103], v[68:71], v[84:87], v[100:103]
    v_mfma_f32_16x16x32_bf16 v[100:103], v[72:75], v[88:91], v[100:103]
    v_mfma_f32_16x16x32_bf16 v[100:103], v[76:79], v[92:95], v[100:103]
    s_nop 7
    s_nop 1
    s_lshl_b32 s40, s2, 11
    s_add_u32 s40, s40, 262144
    s_lshl_b32 s41, s14, 7
    s_add_u32 s40, s40, s41
    v_lshlrev_b32 v9, 2, v2
    s_mov_b64 exec, 0xffff
    buffer_store_dword v100, v9, s[36:39], s40 offen
    buffer_store_dword v101, v9, s[36:39], s40 offen offset:1024
    s_mov_b64 exec, -1
    v_mov_b32 v100, 0
    v_mov_b32 v101, 0
    v_mov_b32 v102, 0
    v_mov_b32 v103, 0
    ds_read_b64_tr_b16 v[80:81], v20 offset:4128
    ds_read_b64_tr_b16 v[82:83], v20 offset:6176
    ds_read_b64_tr_b16 v[84:85], v20 offset:20512
    ds_read_b64_tr_b16 v[86:87], v20 offset:22560
    ds_read_b64_tr_b16 v[88:89], v20 offset:36896
    ds_read_b64_tr_b16 v[90:91], v20 offset:38944
    ds_read_b64_tr_b16 v[92:93], v20 offset:53280
    ds_read_b64_tr_b16 v[94:95], v20 offset:55328
    s_waitcnt lgkmcnt(0)
    v_mfma_f32_16x16x32_bf16 v[100:103], v[64:67], v[80:83], v[100:103]
    v_mfma_f32_16x16x32_bf16 v[100:103], v[68:71], v[84:87], v[100:103]
    v_mfma_f32_16x16x32_bf16 v[100:103], v[72:75], v[88:91], v[100:103]
    v_mfma_f32_16x16x32_bf16 v[100:103], v[76:79], v[92:95], v[100:103]
    s_nop 7
    s_nop 1
    s_lshl_b32 s40, s2, 11
    s_add_u32 s40, s40, 262208
    s_lshl_b32 s41, s14, 7
    s_add_u32 s40, s40, s41
    v_lshlrev_b32 v9, 2, v2
    s_mov_b64 exec, 0xffff
    buffer_store_dword v100, v9, s[36:39], s40 offen
    buffer_store_dword v101, v9, s[36:39], s40 offen offset:1024
    s_mov_b64 exec, -1
    s_cmp_lg_u32 s14, 0
    s_cbranch_scc1 attn_end
    v_mov_b32 v24, v14
    v_mov_b32 v25, v15
    v_mov_b32 v26, v16
    v_mov_b32 v27, v17
    v_mov_b32 v9, 0
    s_lshl_b32 s40, s2, 4
    s_add_u32 s40, s40, 786432
    s_mov_b64 exec, 1
    buffer_store_dwordx4 v[24:27], v9, s[36:39], s40 offen
attn_end:
    s_endpgm
.globl outp_kernel
.p2align 8
.type outp_kernel,@function
outp_kernel:
    s_load_dwordx2 s[4:5], s[0:1], 32
    s_load_dwordx2 s[6:7], s[0:1], 64
    s_load_dwordx2 s[12:13], s[0:1], 88
    v_lshrrev_b32 v1, 6, v0
    v_and_b32 v2, 63, v0
    s_nop 0
    v_readfirstlane_b32 s14, v1
    s_cmp_ge_u32 s2, 256
    s_cbranch_scc1 outp_end
    s_lshr_b32 s15, s2, 4
    s_and_b32 s16, s2, 15
    s_lshr_b32 s17, s15, 1
    s_and_b32 s18, s15, 1
    s_waitcnt lgkmcnt(0)
    s_mov_b32 s20, s4
    s_mov_b32 s21, s5
    s_mov_b32 s22, 3670016
    s_mov_b32 s23, 0x00020000
    s_mov_b32 s24, s6
    s_mov_b32 s25, s7
    s_mov_b32 s26, 1605632
    s_mov_b32 s27, 0x00020000
    s_mov_b32 s36, s12
    s_mov_b32 s37, s13
    s_mov_b32 s38, 1073741824
    s_mov_b32 s39, 0x00020000
    s_lshl_b32 s19, s15, 8
    s_lshl_b32 s40, s16, 4
    s_add_u32 s19, s19, s40
    s_lshl_b32 s40, s14, 1
    s_add_u32 s19, s19, s40
    s_mul_i32 s19, s19, 896
    v_lshlrev_b32 v3, 4, v2
    v_cmp_gt_u32 vcc, 56, v2
    s_and_saveexec_b64 s[42:43], vcc
    buffer_load_dwordx4 v[32:35], v3, s[20:23], s19 offen
    buffer_load_dwordx4 v[36:39], v3, s[20:23], s19 offen offset:896
    s_mul_i32 s44, s2, 7
    s_add_u32 s44, s44, s14
    s_mul_i32 s45, s44, 896
    buffer_load_dwordx4 v[40:43], v3, s[24:27], s45 offen
    s_mov_b64 exec, s[42:43]
    s_lshl_b32 s46, s44, 2
    v_mov_b32 v4, 0
    s_add_u32 s47, s46, 131072
    buffer_load_dword v48, v4, s[36:39], s47 offen
    s_add_u32 s48, s47, 7168
    buffer_load_dword v56, v4, s[36:39], s48 offen
    s_add_u32 s47, s46, 145408
    buffer_load_dword v49, v4, s[36:39], s47 offen
    s_add_u32 s48, s47, 7168
    buffer_load_dword v57, v4, s[36:39], s48 offen
    s_add_u32 s47, s46, 159744
    buffer_load_dword v50, v4, s[36:39], s47 offen
    s_add_u32 s48, s47, 7168
    buffer_load_dword v58, v4, s[36:39], s48 offen
    s_add_u32 s47, s46, 174080
    buffer_load_dword v51, v4, s[36:39], s47 offen
    s_add_u32 s48, s47, 7168
    buffer_load_dword v59, v4, s[36:39], s48 offen
    s_add_u32 s47, s46, 188416
    buffer_load_dword v52, v4, s[36:39], s47 offen
    s_add_u32 s48, s47, 7168
    buffer_load_dword v60, v4, s[36:39], s48 offen
    s_add_u32 s47, s46, 202752
    buffer_load_dword v53, v4, s[36:39], s47 offen
    s_add_u32 s48, s47, 7168
    buffer_load_dword v61, v4, s[36:39], s48 offen
    s_add_u32 s47, s46, 217088
    buffer_load_dword v54, v4, s[36:39], s47 offen
    s_add_u32 s48, s47, 7168
    buffer_load_dword v62, v4, s[36:39], s48 offen
    s_add_u32 s47, s46, 231424
    buffer_load_dword v55, v4, s[36:39], s47 offen
    s_add_u32 s48, s47, 7168
    buffer_load_dword v63, v4, s[36:39], s48 offen
    s_lshl_b32 s47, s17, 9
    s_add_u32 s47, s47, 786432
    v_and_b32 v5, 31, v2
    v_lshlrev_b32 v5, 4, v5
    buffer_load_dwordx4 v[64:67], v5, s[36:39], s47 offen
    v_lshrrev_b32 v6, 4, v0
    v_and_b32 v7, 15, v0
    v_lshlrev_b32 v8, 11, v6
    v_lshlrev_b32 v9, 2, v7
    v_add_u32 v8, v8, v9
    s_lshl_b32 s47, s17, 16
    s_lshl_b32 s48, s18, 10
    s_add_u32 s47, s47, s48
    s_lshl_b32 s48, s16, 6
    s_add_u32 s47, s47, s48
    s_add_u32 s47, s47, 262144
    buffer_load_dword v68, v8, s[36:39], s47 offen
    v_lshlrev_b32 v9, 4, v6
    s_lshl_b32 s47, s17, 9
    s_add_u32 s47, s47, 786432
    buffer_load_dwordx4 v[72:75], v9, s[36:39], s47 offen
    s_waitcnt vmcnt(0)
    s_cmp_eq_u32 s18, 1
    s_cselect_b64 vcc, -1, 0
    v_cndmask_b32 v64, v64, v65, vcc
    v_cndmask_b32 v66, v66, v67, vcc
    v_cndmask_b32 v72, v72, v73, vcc
    v_mov_b32 v76, v64
    s_nop 1
    v_max_f32_dpp v76, v76, v76 quad_perm:[1,0,3,2] row_mask:0xf bank_mask:0xf
    s_nop 1
    v_max_f32_dpp v76, v76, v76 quad_perm:[2,3,0,1] row_mask:0xf bank_mask:0xf
    s_nop 1
    v_max_f32_dpp v76, v76, v76 row_half_mirror row_mask:0xf bank_mask:0xf
    s_nop 1
    v_max_f32_dpp v76, v76, v76 row_mirror row_mask:0xf bank_mask:0xf
    s_nop 1
    v_readlane_b32 s40, v76, 0
    v_readlane_b32 s41, v76, 16
    v_readlane_b32 s42, v76, 32
    v_readlane_b32 s43, v76, 48
    s_nop 1
    v_mov_b32 v76, s40
    v_max_f32 v76, s41, v76
    v_max_f32 v76, s42, v76
    v_max_f32 v76, s43, v76
    v_sub_f32 v64, v64, v76
    v_mul_f32 v64, 0x3fb8aa3b, v64
    v_exp_f32 v64, v64
    s_nop 0
    v_mul_f32 v64, v64, v66
    v_cmp_gt_u32 vcc, 32, v2
    s_nop 1
    v_cndmask_b32 v64, 0, v64, vcc
    s_nop 1
    v_add_f32_dpp v64, v64, v64 quad_perm:[1,0,3,2] row_mask:0xf bank_mask:0xf
    s_nop 1
    v_add_f32_dpp v64, v64, v64 quad_perm:[2,3,0,1] row_mask:0xf bank_mask:0xf
    s_nop 1
    v_add_f32_dpp v64, v64, v64 row_half_mirror row_mask:0xf bank_mask:0xf
    s_nop 1
    v_add_f32_dpp v64, v64, v64 row_mirror row_mask:0xf bank_mask:0xf
    s_nop 1
    v_readlane_b32 s40, v64, 0
    v_readlane_b32 s41, v64, 16
    v_readlane_b32 s42, v64, 32
    v_readlane_b32 s43, v64, 48
    s_nop 1
    v_mov_b32 v64, s40
    v_add_f32 v64, s41, v64
    v_add_f32 v64, s42, v64
    v_add_f32 v64, s43, v64
    v_rcp_f32 v64, v64
    v_sub_f32 v72, v72, v76
    v_mul_f32 v72, 0x3fb8aa3b, v72
    v_exp_f32 v72, v72
    s_nop 0
    v_mul_f32 v68, v68, v72
    v_mul_f32 v68, v68, v64
    v_lshlrev_b32 v9, 2, v0
    ds_write_b32 v9, v68 offset:0
    s_waitcnt lgkmcnt(0)
    s_barrier
    v_and_b32 v9, 31, v2
    v_lshlrev_b32 v9, 6, v9
    s_lshl_b32 s47, s14, 3
    v_add_u32 v9, s47, v9
    ds_read_b64 v[70:71], v9 offset:0
    s_waitcnt lgkmcnt(0)
    v_cmp_gt_u32 vcc, 32, v2
    s_nop 1
    v_cndmask_b32 v70, 0, v70, vcc
    v_cndmask_b32 v71, 0, v71, vcc
    s_nop 1
    v_add_f32_dpp v70, v70, v70 quad_perm:[1,0,3,2] row_mask:0xf bank_mask:0xf
    s_nop 1
    v_add_f32_dpp v70, v70, v70 quad_perm:[2,3,0,1] row_mask:0xf bank_mask:0xf
    s_nop 1
    v_add_f32_dpp v70, v70, v70 row_half_mirror row_mask:0xf bank_mask:0xf
    s_nop 1
    v_add_f32_dpp v70, v70, v70 row_mirror row_mask:0xf bank_mask:0xf
    s_nop 1
    v_readlane_b32 s40, v70, 0
    v_readlane_b32 s41, v70, 16
    v_readlane_b32 s42, v70, 32
    v_readlane_b32 s43, v70, 48
    s_nop 1
    v_mov_b32 v70, s40
    v_add_f32 v70, s41, v70
    v_add_f32 v70, s42, v70
    v_add_f32 v70, s43, v70
    s_nop 1
    v_add_f32_dpp v71, v71, v71 quad_perm:[1,0,3,2] row_mask:0xf bank_mask:0xf
    s_nop 1
    v_add_f32_dpp v71, v71, v71 quad_perm:[2,3,0,1] row_mask:0xf bank_mask:0xf
    s_nop 1
    v_add_f32_dpp v71, v71, v71 row_half_mirror row_mask:0xf bank_mask:0xf
    s_nop 1
    v_add_f32_dpp v71, v71, v71 row_mirror row_mask:0xf bank_mask:0xf
    s_nop 1
    v_readlane_b32 s40, v71, 0
    v_readlane_b32 s41, v71, 16
    v_readlane_b32 s42, v71, 32
    v_readlane_b32 s43, v71, 48
    s_nop 1
    v_mov_b32 v71, s40
    v_add_f32 v71, s41, v71
    v_add_f32 v71, s42, v71
    v_add_f32 v71, s43, v71
    v_cvt_pk_bf16_f32 v70, v70, v70
    v_lshlrev_b32 v70, 16, v70
    v_cvt_pk_bf16_f32 v71, v71, v71
    v_lshlrev_b32 v71, 16, v71
    v_lshlrev_b32 v80, 16, v32
    v_and_b32 v81, 0xffff0000, v32
    v_mul_f32 v84, v80, v70
    v_mul_f32 v85, v81, v70
    v_lshlrev_b32 v80, 16, v36
    v_and_b32 v81, 0xffff0000, v36
    v_fmac_f32 v84, v80, v71
    v_fmac_f32 v85, v81, v71
    v_lshlrev_b32 v80, 16, v33
    v_and_b32 v81, 0xffff0000, v33
    v_mul_f32 v86, v80, v70
    v_mul_f32 v87, v81, v70
    v_lshlrev_b32 v80, 16, v37
    v_and_b32 v81, 0xffff0000, v37
    v_fmac_f32 v86, v80, v71
    v_fmac_f32 v87, v81, v71
    v_lshlrev_b32 v80, 16, v34
    v_and_b32 v81, 0xffff0000, v34
    v_mul_f32 v88, v80, v70
    v_mul_f32 v89, v81, v70
    v_lshlrev_b32 v80, 16, v38
    v_and_b32 v81, 0xffff0000, v38
    v_fmac_f32 v88, v80, v71
    v_fmac_f32 v89, v81, v71
    v_lshlrev_b32 v80, 16, v35
    v_and_b32 v81, 0xffff0000, v35
    v_mul_f32 v90, v80, v70
    v_mul_f32 v91, v81, v70
    v_lshlrev_b32 v80, 16, v39
    v_and_b32 v81, 0xffff0000, v39
    v_fmac_f32 v90, v80, v71
    v_fmac_f32 v91, v81, v71
    v_add_f32 v48, v48, v49
    v_add_f32 v56, v56, v57
    v_add_f32 v48, v48, v50
    v_add_f32 v56, v56, v58
    v_add_f32 v48, v48, v51
    v_add_f32 v56, v56, v59
    v_add_f32 v48, v48, v52
    v_add_f32 v56, v56, v60
    v_add_f32 v48, v48, v53
    v_add_f32 v56, v56, v61
    v_add_f32 v48, v48, v54
    v_add_f32 v56, v56, v62
    v_add_f32 v48, v48, v55
    v_add_f32 v56, v56, v63
    v_cvt_pk_bf16_f32 v48, v48, v48
    v_lshlrev_b32 v48, 16, v48
    v_cvt_pk_bf16_f32 v56, v56, v56
    v_lshlrev_b32 v56, 16, v56
    v_mul_f32 v49, 0xbfb8aa3b, v48
    v_exp_f32 v49, v49
    s_nop 0
    v_add_f32 v49, 1.0, v49
    v_rcp_f32 v49, v49
    s_nop 0
    v_cvt_pk_bf16_f32 v49, v49, v49
    v_lshlrev_b32 v49, 16, v49
    v_mul_f32 v49, v49, v56
    v_cvt_pk_bf16_f32 v49, v49, v49
    v_lshlrev_b32 v49, 16, v49
    v_lshlrev_b32 v80, 16, v40
    v_and_b32 v81, 0xffff0000, v40
    v_mul_f32 v92, v80, v49
    v_mul_f32 v93, v81, v49
    v_lshlrev_b32 v80, 16, v41
    v_and_b32 v81, 0xffff0000, v41
    v_mul_f32 v94, v80, v49
    v_mul_f32 v95, v81, v49
    v_lshlrev_b32 v80, 16, v42
    v_and_b32 v81, 0xffff0000, v42
    v_mul_f32 v96, v80, v49
    v_mul_f32 v97, v81, v49
    v_lshlrev_b32 v80, 16, v43
    v_and_b32 v81, 0xffff0000, v43
    v_mul_f32 v98, v80, v49
    v_mul_f32 v99, v81, v49
    s_mul_i32 s47, s14, 1792
    v_lshlrev_b32 v9, 5, v2
    v_add_u32 v9, s47, v9
    v_cmp_gt_u32 vcc, 56, v2
    s_and_saveexec_b64 s[42:43], vcc
    ds_write_b128 v9, v[84:87] offset:2048
    ds_write_b128 v9, v[88:91] offset:2064
    s_cmp_ge_u32 s14, 7
    s_cbranch_scc1 outp_skipb
    ds_write_b128 v9, v[92:95] offset:16384
    ds_write_b128 v9, v[96:99] offset:16400
outp_skipb:
    s_mov_b64 exec, s[42:43]
    s_waitcnt lgkmcnt(0)
    s_barrier
    v_cmp_gt_u32 vcc, 448, v0
    s_and_saveexec_b64 s[42:43], vcc
    s_cbranch_execz outp_end
    v_lshlrev_b32 v9, 2, v0
    ds_read_b32 v100, v9 offset:2048
    ds_read_b32 v101, v9 offset:3840
    ds_read_b32 v102, v9 offset:5632
    ds_read_b32 v103, v9 offset:7424
    ds_read_b32 v104, v9 offset:9216
    ds_read_b32 v105, v9 offset:11008
    ds_read_b32 v106, v9 offset:12800
    ds_read_b32 v107, v9 offset:14592
    ds_read_b32 v108, v9 offset:16384
    ds_read_b32 v109, v9 offset:18176
    ds_read_b32 v110, v9 offset:19968
    ds_read_b32 v111, v9 offset:21760
    ds_read_b32 v112, v9 offset:23552
    ds_read_b32 v113, v9 offset:25344
    ds_read_b32 v114, v9 offset:27136
    s_waitcnt lgkmcnt(0)
    v_add_f32 v100, v100, v101
    v_add_f32 v100, v100, v102
    v_add_f32 v100, v100, v103
    v_add_f32 v100, v100, v104
    v_add_f32 v100, v100, v105
    v_add_f32 v100, v100, v106
    v_add_f32 v100, v100, v107
    v_add_f32 v108, v108, v109
    v_add_f32 v108, v108, v110
    v_add_f32 v108, v108, v111
    v_add_f32 v108, v108, v112
    v_add_f32 v108, v108, v113
    v_add_f32 v108, v108, v114
    s_mul_i32 s47, s2, 3584
    s_add_u32 s47, s47, 1048576
    buffer_store_dword v100, v9, s[36:39], s47 offen
    buffer_store_dword v108, v9, s[36:39], s47 offen offset:1792
outp_end:
    s_endpgm
.globl final_kernel
.p2align 8
.type final_kernel,@function
final_kernel:
    s_load_dwordx2 s[4:5], s[0:1], 0
    s_load_dwordx2 s[6:7], s[0:1], 72
    s_load_dwordx2 s[12:13], s[0:1], 88
    s_cmp_ge_u32 s2, 7
    s_cbranch_scc1 final_end
    s_waitcnt lgkmcnt(0)
    s_mov_b32 s20, s4
    s_mov_b32 s21, s5
    s_mov_b32 s22, 896
    s_mov_b32 s23, 0x00020000
    s_mov_b32 s24, s6
    s_mov_b32 s25, s7
    s_mov_b32 s26, 896
    s_mov_b32 s27, 0x00020000
    s_mov_b32 s36, s12
    s_mov_b32 s37, s13
    s_mov_b32 s38, 1073741824
    s_mov_b32 s39, 0x00020000
    s_lshl_b32 s15, s2, 6
    v_add_u32 v1, s15, v0
    v_lshlrev_b32 v2, 2, v1
    v_mov_b32 v3, 0
    v_mov_b32 v4, 0
    s_mov_b32 s16, 1048576
    s_mov_b32 s17, 0
final_loop:
    buffer_load_dword v10, v2, s[36:39], s16 offen offset:0
    buffer_load_dword v11, v2, s[36:39], s16 offen offset:1792
    s_add_u32 s16, s16, 3584
    buffer_load_dword v12, v2, s[36:39], s16 offen offset:0
    buffer_load_dword v13, v2, s[36:39], s16 offen offset:1792
    s_add_u32 s16, s16, 3584
    buffer_load_dword v14, v2, s[36:39], s16 offen offset:0
    buffer_load_dword v15, v2, s[36:39], s16 offen offset:1792
    s_add_u32 s16, s16, 3584
    buffer_load_dword v16, v2, s[36:39], s16 offen offset:0
    buffer_load_dword v17, v2, s[36:39], s16 offen offset:1792
    s_add_u32 s16, s16, 3584
    buffer_load_dword v18, v2, s[36:39], s16 offen offset:0
    buffer_load_dword v19, v2, s[36:39], s16 offen offset:1792
    s_add_u32 s16, s16, 3584
    buffer_load_dword v20, v2, s[36:39], s16 offen offset:0
    buffer_load_dword v21, v2, s[36:39], s16 offen offset:1792
    s_add_u32 s16, s16, 3584
    buffer_load_dword v22, v2, s[36:39], s16 offen offset:0
    buffer_load_dword v23, v2, s[36:39], s16 offen offset:1792
    s_add_u32 s16, s16, 3584
    buffer_load_dword v24, v2, s[36:39], s16 offen offset:0
    buffer_load_dword v25, v2, s[36:39], s16 offen offset:1792
    s_add_u32 s16, s16, 3584
    s_waitcnt vmcnt(0)
    v_add_f32 v3, v3, v10
    v_add_f32 v4, v4, v11
    v_add_f32 v3, v3, v12
    v_add_f32 v4, v4, v13
    v_add_f32 v3, v3, v14
    v_add_f32 v4, v4, v15
    v_add_f32 v3, v3, v16
    v_add_f32 v4, v4, v17
    v_add_f32 v3, v3, v18
    v_add_f32 v4, v4, v19
    v_add_f32 v3, v3, v20
    v_add_f32 v4, v4, v21
    v_add_f32 v3, v3, v22
    v_add_f32 v4, v4, v23
    v_add_f32 v3, v3, v24
    v_add_f32 v4, v4, v25
    s_add_u32 s17, s17, 8
    s_cmp_lt_u32 s17, 256
    s_cbranch_scc1 final_loop
    v_lshlrev_b32 v2, 1, v1
    buffer_load_ushort v5, v2, s[20:23], 0 offen
    v_cvt_pk_bf16_f32 v3, v3, v3
    v_lshlrev_b32 v3, 16, v3
    v_cvt_pk_bf16_f32 v4, v4, v4
    v_lshlrev_b32 v4, 16, v4
    s_waitcnt vmcnt(0)
    v_lshlrev_b32 v5, 16, v5
    v_add_f32 v5, v5, v3
    v_cvt_pk_bf16_f32 v5, v5, v5
    v_lshlrev_b32 v5, 16, v5
    v_add_f32 v5, v5, v4
    v_cvt_pk_bf16_f32 v5, v5, v5
    buffer_store_short v5, v2, s[24:27], 0 offen
final_end:
    s_endpgm
.section .rodata,"a"
.p2align 6
.amdhsa_kernel proj_kernel
  .amdhsa_next_free_vgpr 128
  .amdhsa_next_free_sgpr 96
  .amdhsa_accum_offset 128
  .amdhsa_group_segment_fixed_size 0
  .amdhsa_kernarg_size 96
  .amdhsa_user_sgpr_count 2
  .amdhsa_user_sgpr_kernarg_segment_ptr 1
  .amdhsa_system_sgpr_workgroup_id_x 1
.end_amdhsa_kernel
.p2align 6
.amdhsa_kernel attn_kernel
  .amdhsa_next_free_vgpr 128
  .amdhsa_next_free_sgpr 96
  .amdhsa_accum_offset 128
  .amdhsa_group_segment_fixed_size 0
  .amdhsa_kernarg_size 96
  .amdhsa_user_sgpr_count 2
  .amdhsa_user_sgpr_kernarg_segment_ptr 1
  .amdhsa_system_sgpr_workgroup_id_x 1
.end_amdhsa_kernel
.p2align 6
.amdhsa_kernel outp_kernel
  .amdhsa_next_free_vgpr 128
  .amdhsa_next_free_sgpr 96
  .amdhsa_accum_offset 128
  .amdhsa_group_segment_fixed_size 0
  .amdhsa_kernarg_size 96
  .amdhsa_user_sgpr_count 2
  .amdhsa_user_sgpr_kernarg_segment_ptr 1
  .amdhsa_system_sgpr_workgroup_id_x 1
.end_amdhsa_kernel
.p2align 6
.amdhsa_kernel final_kernel
  .amdhsa_next_free_vgpr 128
  .amdhsa_next_free_sgpr 96
  .amdhsa_accum_offset 128
  .amdhsa_group_segment_fixed_size 0
  .amdhsa_kernarg_size 96
  .amdhsa_user_sgpr_count 2
  .amdhsa_user_sgpr_kernarg_segment_ptr 1
  .amdhsa_system_sgpr_workgroup_id_x 1
.end_amdhsa_kernel
```

```asm
; @launch kernel=proj_kernel grid=(240,1,1) block=(256,1,1) lds=8192
; @launch kernel=attn_kernel grid=(256,1,1) block=(512,1,1) lds=69632
; @launch kernel=outp_kernel grid=(256,1,1) block=(512,1,1) lds=32768
; @launch kernel=final_kernel grid=(7,1,1) block=(1024,1,1) lds=8192
.amdgcn_target "amdgcn-amd-amdhsa--gfx950"
.text
.globl proj_kernel
.p2align 8
.type proj_kernel,@function
proj_kernel:
    s_load_dwordx2 s[4:5], s[0:1], 0
    s_load_dwordx2 s[6:7], s[0:1], 24
    s_load_dwordx2 s[8:9], s[0:1], 48
    s_load_dwordx2 s[10:11], s[0:1], 56
    s_load_dwordx2 s[12:13], s[0:1], 88
    v_lshrrev_b32 v1, 6, v0
    v_and_b32 v2, 63, v0
    s_nop 0
    v_readfirstlane_b32 s14, v1
    s_cmp_ge_u32 s2, 240
    s_cbranch_scc1 proj_end
    s_lshl_b32 s15, s2, 2
    s_add_u32 s15, s15, s14
    s_lshr_b32 s16, s15, 3
    s_and_b32 s17, s15, 7
    s_waitcnt lgkmcnt(0)
    s_cmp_lt_u32 s16, 64
    s_cbranch_scc0 proj_notq
    s_mov_b32 s18, s6
    s_mov_b32 s19, s7
    s_mov_b32 s20, 8192
    s_lshl_b32 s21, s16, 7
    s_lshl_b32 s22, s17, 14
    s_lshl_b32 s24, s16, 8
    s_add_u32 s22, s22, s24
    s_add_u32 s22, s22, 0
    s_mov_b32 s23, 3670016
    s_branch proj_sel_done
proj_notq:
    s_mov_b32 s20, 3584
    s_mov_b32 s23, 1605632
    s_sub_u32 s24, s16, 64
    s_mul_i32 s22, s17, 14336
    s_lshl_b32 s25, s24, 8
    s_add_u32 s22, s22, s25
    s_add_u32 s22, s22, 131072
    s_cmp_lt_u32 s16, 92
    s_cbranch_scc0 proj_up
    s_mov_b32 s18, s8
    s_mov_b32 s19, s9
    s_lshl_b32 s21, s24, 7
    s_branch proj_sel_done
proj_up:
    s_mov_b32 s18, s10
    s_mov_b32 s19, s11
    s_sub_u32 s25, s16, 92
    s_lshl_b32 s21, s25, 7
proj_sel_done:
    s_mov_b32 s28, s18
    s_mov_b32 s29, s19
    s_mov_b32 s30, s23
    s_mov_b32 s31, 0x00020000
    s_mov_b32 s32, s4
    s_mov_b32 s33, s5
    s_mov_b32 s34, 896
    s_mov_b32 s35, 0x00020000
    s_mov_b32 s36, s12
    s_mov_b32 s37, s13
    s_mov_b32 s38, 1073741824
    s_mov_b32 s39, 0x00020000
    v_lshlrev_b32 v3, 1, v2
    buffer_load_ushort v10, v3, s[32:35], 0 offen offset:0
    buffer_load_ushort v11, v3, s[32:35], 0 offen offset:128
    buffer_load_ushort v12, v3, s[32:35], 0 offen offset:256
    buffer_load_ushort v13, v3, s[32:35], 0 offen offset:384
    buffer_load_ushort v14, v3, s[32:35], 0 offen offset:512
    buffer_load_ushort v15, v3, s[32:35], 0 offen offset:640
    buffer_load_ushort v16, v3, s[32:35], 0 offen offset:768
    v_lshrrev_b32 v4, 3, v2
    s_mul_i32 s24, s17, 56
    v_add_u32 v5, s24, v4
    v_lshlrev_b32 v5, 1, v5
    buffer_load_ushort v20, v5, s[32:35], 0 offen offset:0
    buffer_load_ushort v21, v5, s[32:35], 0 offen offset:16
    buffer_load_ushort v22, v5, s[32:35], 0 offen offset:32
    buffer_load_ushort v23, v5, s[32:35], 0 offen offset:48
    buffer_load_ushort v24, v5, s[32:35], 0 offen offset:64
    buffer_load_ushort v25, v5, s[32:35], 0 offen offset:80
    buffer_load_ushort v26, v5, s[32:35], 0 offen offset:96
    v_mul_lo_u32 v6, v4, s20
    v_and_b32 v7, 7, v2
    v_lshlrev_b32 v7, 4, v7
    v_add_u32 v6, v6, v7
    s_mul_i32 s24, s24, s20
    s_add_u32 s24, s24, s21
    s_lshl_b32 s25, s20, 3
    buffer_load_dwordx4 v[32:35], v6, s[28:31], s24 offen
    s_add_u32 s24, s24, s25
    buffer_load_dwordx4 v[36:39], v6, s[28:31], s24 offen
    s_add_u32 s24, s24, s25
    buffer_load_dwordx4 v[40:43], v6, s[28:31], s24 offen
    s_add_u32 s24, s24, s25
    buffer_load_dwordx4 v[44:47], v6, s[28:31], s24 offen
    s_add_u32 s24, s24, s25
    buffer_load_dwordx4 v[48:51], v6, s[28:31], s24 offen
    s_add_u32 s24, s24, s25
    buffer_load_dwordx4 v[52:55], v6, s[28:31], s24 offen
    s_add_u32 s24, s24, s25
    buffer_load_dwordx4 v[56:59], v6, s[28:31], s24 offen
    s_waitcnt vmcnt(14)
    v_lshlrev_b32 v10, 16, v10
    v_lshlrev_b32 v11, 16, v11
    v_lshlrev_b32 v12, 16, v12
    v_lshlrev_b32 v13, 16, v13
    v_lshlrev_b32 v14, 16, v14
    v_lshlrev_b32 v15, 16, v15
    v_lshlrev_b32 v16, 16, v16
    v_add_f32 v8, v10, v11
    v_add_f32 v8, v8, v12
    v_add_f32 v8, v8, v13
    v_add_f32 v8, v8, v14
    v_add_f32 v8, v8, v15
    v_add_f32 v8, v8, v16
    s_nop 1
    v_add_f32_dpp v8, v8, v8 quad_perm:[1,0,3,2] row_mask:0xf bank_mask:0xf
    s_nop 1
    v_add_f32_dpp v8, v8, v8 quad_perm:[2,3,0,1] row_mask:0xf bank_mask:0xf
    s_nop 1
    v_add_f32_dpp v8, v8, v8 row_half_mirror row_mask:0xf bank_mask:0xf
    s_nop 1
    v_add_f32_dpp v8, v8, v8 row_mirror row_mask:0xf bank_mask:0xf
    s_nop 1
    v_readlane_b32 s40, v8, 0
    v_readlane_b32 s41, v8, 16
    v_readlane_b32 s42, v8, 32
    v_readlane_b32 s43, v8, 48
    s_nop 1
    v_mov_b32 v8, s40
    v_add_f32 v8, s41, v8
    v_add_f32 v8, s42, v8
    v_add_f32 v8, s43, v8
    v_mul_f32 v8, 0x3b124925, v8
    v_sub_f32 v9, v10, v8
    v_mul_f32 v9, v9, v9
    v_sub_f32 v17, v11, v8
    v_fmac_f32 v9, v17, v17
    v_sub_f32 v17, v12, v8
    v_fmac_f32 v9, v17, v17
    v_sub_f32 v17, v13, v8
    v_fmac_f32 v9, v17, v17
    v_sub_f32 v17, v14, v8
    v_fmac_f32 v9, v17, v17
    v_sub_f32 v17, v15, v8
    v_fmac_f32 v9, v17, v17
    v_sub_f32 v17, v16, v8
    v_fmac_f32 v9, v17, v17
    s_nop 1
    v_add_f32_dpp v9, v9, v9 quad_perm:[1,0,3,2] row_mask:0xf bank_mask:0xf
    s_nop 1
    v_add_f32_dpp v9, v9, v9 quad_perm:[2,3,0,1] row_mask:0xf bank_mask:0xf
    s_nop 1
    v_add_f32_dpp v9, v9, v9 row_half_mirror row_mask:0xf bank_mask:0xf
    s_nop 1
    v_add_f32_dpp v9, v9, v9 row_mirror row_mask:0xf bank_mask:0xf
    s_nop 1
    v_readlane_b32 s40, v9, 0
    v_readlane_b32 s41, v9, 16
    v_readlane_b32 s42, v9, 32
    v_readlane_b32 s43, v9, 48
    s_nop 1
    v_mov_b32 v9, s40
    v_add_f32 v9, s41, v9
    v_add_f32 v9, s42, v9
    v_add_f32 v9, s43, v9
    v_mul_f32 v9, 0x3b124925, v9
    v_cvt_pk_bf16_f32 v8, v8, v8
    v_lshlrev_b32 v8, 16, v8
    v_cvt_pk_bf16_f32 v9, v9, v9
    v_lshlrev_b32 v9, 16, v9
    v_add_f32 v9, 0x3727c5ac, v9
    v_cvt_pk_bf16_f32 v9, v9, v9
    v_lshlrev_b32 v9, 16, v9
    v_sqrt_f32 v9, v9
    s_nop 0
    v_cvt_pk_bf16_f32 v9, v9, v9
    v_lshlrev_b32 v9, 16, v9
    v_rcp_f32 v9, v9
    s_waitcnt vmcnt(7)
    v_lshlrev_b32 v20, 16, v20
    v_sub_f32 v20, v20, v8
    v_cvt_pk_bf16_f32 v20, v20, v20
    v_lshlrev_b32 v20, 16, v20
    v_mul_f32 v20, v20, v9
    v_cvt_pk_bf16_f32 v20, v20, v20
    v_lshlrev_b32 v20, 16, v20
    v_lshlrev_b32 v21, 16, v21
    v_sub_f32 v21, v21, v8
    v_cvt_pk_bf16_f32 v21, v21, v21
    v_lshlrev_b32 v21, 16, v21
    v_mul_f32 v21, v21, v9
    v_cvt_pk_bf16_f32 v21, v21, v21
    v_lshlrev_b32 v21, 16, v21
    v_lshlrev_b32 v22, 16, v22
    v_sub_f32 v22, v22, v8
    v_cvt_pk_bf16_f32 v22, v22, v22
    v_lshlrev_b32 v22, 16, v22
    v_mul_f32 v22, v22, v9
    v_cvt_pk_bf16_f32 v22, v22, v22
    v_lshlrev_b32 v22, 16, v22
    v_lshlrev_b32 v23, 16, v23
    v_sub_f32 v23, v23, v8
    v_cvt_pk_bf16_f32 v23, v23, v23
    v_lshlrev_b32 v23, 16, v23
    v_mul_f32 v23, v23, v9
    v_cvt_pk_bf16_f32 v23, v23, v23
    v_lshlrev_b32 v23, 16, v23
    v_lshlrev_b32 v24, 16, v24
    v_sub_f32 v24, v24, v8
    v_cvt_pk_bf16_f32 v24, v24, v24
    v_lshlrev_b32 v24, 16, v24
    v_mul_f32 v24, v24, v9
    v_cvt_pk_bf16_f32 v24, v24, v24
    v_lshlrev_b32 v24, 16, v24
    v_lshlrev_b32 v25, 16, v25
    v_sub_f32 v25, v25, v8
    v_cvt_pk_bf16_f32 v25, v25, v25
    v_lshlrev_b32 v25, 16, v25
    v_mul_f32 v25, v25, v9
    v_cvt_pk_bf16_f32 v25, v25, v25
    v_lshlrev_b32 v25, 16, v25
    v_lshlrev_b32 v26, 16, v26
    v_sub_f32 v26, v26, v8
    v_cvt_pk_bf16_f32 v26, v26, v26
    v_lshlrev_b32 v26, 16, v26
    v_mul_f32 v26, v26, v9
    v_cvt_pk_bf16_f32 v26, v26, v26
    v_lshlrev_b32 v26, 16, v26
    v_mov_b32 v64, 0
    v_mov_b32 v65, 0
    v_mov_b32 v66, 0
    v_mov_b32 v67, 0
    v_mov_b32 v68, 0
    v_mov_b32 v69, 0
    v_mov_b32 v70, 0
    v_mov_b32 v71, 0
    s_waitcnt vmcnt(6)
    v_lshlrev_b32 v72, 16, v32
    v_and_b32 v73, 0xffff0000, v32
    v_fmac_f32 v64, v72, v20
    v_fmac_f32 v65, v73, v20
    v_lshlrev_b32 v72, 16, v33
    v_and_b32 v73, 0xffff0000, v33
    v_fmac_f32 v66, v72, v20
    v_fmac_f32 v67, v73, v20
    v_lshlrev_b32 v72, 16, v34
    v_and_b32 v73, 0xffff0000, v34
    v_fmac_f32 v68, v72, v20
    v_fmac_f32 v69, v73, v20
    v_lshlrev_b32 v72, 16, v35
    v_and_b32 v73, 0xffff0000, v35
    v_fmac_f32 v70, v72, v20
    v_fmac_f32 v71, v73, v20
    s_waitcnt vmcnt(5)
    v_lshlrev_b32 v72, 16, v36
    v_and_b32 v73, 0xffff0000, v36
    v_fmac_f32 v64, v72, v21
    v_fmac_f32 v65, v73, v21
    v_lshlrev_b32 v72, 16, v37
    v_and_b32 v73, 0xffff0000, v37
    v_fmac_f32 v66, v72, v21
    v_fmac_f32 v67, v73, v21
    v_lshlrev_b32 v72, 16, v38
    v_and_b32 v73, 0xffff0000, v38
    v_fmac_f32 v68, v72, v21
    v_fmac_f32 v69, v73, v21
    v_lshlrev_b32 v72, 16, v39
    v_and_b32 v73, 0xffff0000, v39
    v_fmac_f32 v70, v72, v21
    v_fmac_f32 v71, v73, v21
    s_waitcnt vmcnt(4)
    v_lshlrev_b32 v72, 16, v40
    v_and_b32 v73, 0xffff0000, v40
    v_fmac_f32 v64, v72, v22
    v_fmac_f32 v65, v73, v22
    v_lshlrev_b32 v72, 16, v41
    v_and_b32 v73, 0xffff0000, v41
    v_fmac_f32 v66, v72, v22
    v_fmac_f32 v67, v73, v22
    v_lshlrev_b32 v72, 16, v42
    v_and_b32 v73, 0xffff0000, v42
    v_fmac_f32 v68, v72, v22
    v_fmac_f32 v69, v73, v22
    v_lshlrev_b32 v72, 16, v43
    v_and_b32 v73, 0xffff0000, v43
    v_fmac_f32 v70, v72, v22
    v_fmac_f32 v71, v73, v22
    s_waitcnt vmcnt(3)
    v_lshlrev_b32 v72, 16, v44
    v_and_b32 v73, 0xffff0000, v44
    v_fmac_f32 v64, v72, v23
    v_fmac_f32 v65, v73, v23
    v_lshlrev_b32 v72, 16, v45
    v_and_b32 v73, 0xffff0000, v45
    v_fmac_f32 v66, v72, v23
    v_fmac_f32 v67, v73, v23
    v_lshlrev_b32 v72, 16, v46
    v_and_b32 v73, 0xffff0000, v46
    v_fmac_f32 v68, v72, v23
    v_fmac_f32 v69, v73, v23
    v_lshlrev_b32 v72, 16, v47
    v_and_b32 v73, 0xffff0000, v47
    v_fmac_f32 v70, v72, v23
    v_fmac_f32 v71, v73, v23
    s_waitcnt vmcnt(2)
    v_lshlrev_b32 v72, 16, v48
    v_and_b32 v73, 0xffff0000, v48
    v_fmac_f32 v64, v72, v24
    v_fmac_f32 v65, v73, v24
    v_lshlrev_b32 v72, 16, v49
    v_and_b32 v73, 0xffff0000, v49
    v_fmac_f32 v66, v72, v24
    v_fmac_f32 v67, v73, v24
    v_lshlrev_b32 v72, 16, v50
    v_and_b32 v73, 0xffff0000, v50
    v_fmac_f32 v68, v72, v24
    v_fmac_f32 v69, v73, v24
    v_lshlrev_b32 v72, 16, v51
    v_and_b32 v73, 0xffff0000, v51
    v_fmac_f32 v70, v72, v24
    v_fmac_f32 v71, v73, v24
    s_waitcnt vmcnt(1)
    v_lshlrev_b32 v72, 16, v52
    v_and_b32 v73, 0xffff0000, v52
    v_fmac_f32 v64, v72, v25
    v_fmac_f32 v65, v73, v25
    v_lshlrev_b32 v72, 16, v53
    v_and_b32 v73, 0xffff0000, v53
    v_fmac_f32 v66, v72, v25
    v_fmac_f32 v67, v73, v25
    v_lshlrev_b32 v72, 16, v54
    v_and_b32 v73, 0xffff0000, v54
    v_fmac_f32 v68, v72, v25
    v_fmac_f32 v69, v73, v25
    v_lshlrev_b32 v72, 16, v55
    v_and_b32 v73, 0xffff0000, v55
    v_fmac_f32 v70, v72, v25
    v_fmac_f32 v71, v73, v25
    s_waitcnt vmcnt(0)
    v_lshlrev_b32 v72, 16, v56
    v_and_b32 v73, 0xffff0000, v56
    v_fmac_f32 v64, v72, v26
    v_fmac_f32 v65, v73, v26
    v_lshlrev_b32 v72, 16, v57
    v_and_b32 v73, 0xffff0000, v57
    v_fmac_f32 v66, v72, v26
    v_fmac_f32 v67, v73, v26
    v_lshlrev_b32 v72, 16, v58
    v_and_b32 v73, 0xffff0000, v58
    v_fmac_f32 v68, v72, v26
    v_fmac_f32 v69, v73, v26
    v_lshlrev_b32 v72, 16, v59
    v_and_b32 v73, 0xffff0000, v59
    v_fmac_f32 v70, v72, v26
    v_fmac_f32 v71, v73, v26
    s_lshl_b32 s24, s14, 11
    v_lshlrev_b32 v74, 8, v4
    v_lshlrev_b32 v75, 1, v7
    v_add3_u32 v74, v74, v75, s24
    ds_write_b128 v74, v[64:67]
    ds_write_b128 v74, v[68:71] offset:16
    v_lshlrev_b32 v76, 2, v2
    v_add_u32 v77, s24, v76
    s_waitcnt lgkmcnt(0)
    ds_read_b32 v80, v77 offset:0
    ds_read_b32 v81, v77 offset:256
    ds_read_b32 v82, v77 offset:512
    ds_read_b32 v83, v77 offset:768
    ds_read_b32 v84, v77 offset:1024
    ds_read_b32 v85, v77 offset:1280
    ds_read_b32 v86, v77 offset:1536
    ds_read_b32 v87, v77 offset:1792
    s_waitcnt lgkmcnt(0)
    v_add_f32 v80, v80, v81
    v_add_f32 v80, v80, v82
    v_add_f32 v80, v80, v83
    v_add_f32 v80, v80, v84
    v_add_f32 v80, v80, v85
    v_add_f32 v80, v80, v86
    v_add_f32 v80, v80, v87
    buffer_store_dword v80, v76, s[36:39], s22 offen
proj_end:
    s_endpgm
.globl attn_kernel
.p2align 8
.type attn_kernel,@function
attn_kernel:
    s_load_dwordx4 s[4:7], s[0:1], 8
    s_load_dwordx2 s[12:13], s[0:1], 88
    v_lshrrev_b32 v1, 6, v0
    v_and_b32 v2, 63, v0
    s_nop 0
    v_readfirstlane_b32 s14, v1
    s_cmp_ge_u32 s2, 256
    s_cbranch_scc1 attn_end
    s_lshr_b32 s15, s2, 5
    s_and_b32 s16, s2, 31
    s_waitcnt lgkmcnt(0)
    s_lshl_b32 s17, s15, 25
    s_lshl_b32 s18, s16, 16
    s_add_u32 s17, s17, s18
    s_add_u32 s17, s17, 31457280
    s_add_u32 s4, s4, s17
    s_addc_u32 s5, s5, 0
    s_add_u32 s6, s6, s17
    s_addc_u32 s7, s7, 0
    s_mov_b32 s20, s4
    s_mov_b32 s21, s5
    s_mov_b32 s22, 65536
    s_mov_b32 s23, 0x00020000
    s_mov_b32 s24, s6
    s_mov_b32 s25, s7
    s_mov_b32 s26, 65536
    s_mov_b32 s27, 0x00020000
    s_mov_b32 s36, s12
    s_mov_b32 s37, s13
    s_mov_b32 s38, 1073741824
    s_mov_b32 s39, 0x00020000
    v_and_b32 v3, 15, v2
    v_lshrrev_b32 v4, 4, v2
    s_lshl_b32 s18, s14, 13
    v_lshlrev_b32 v5, 9, v3
    v_lshlrev_b32 v6, 4, v4
    v_add3_u32 v5, v5, v6, s18
    buffer_load_dwordx4 v[32:35], v5, s[20:23], 0 offen offset:0
    buffer_load_dwordx4 v[36:39], v5, s[20:23], 0 offen offset:64
    buffer_load_dwordx4 v[40:43], v5, s[20:23], 0 offen offset:128
    buffer_load_dwordx4 v[44:47], v5, s[20:23], 0 offen offset:192
    buffer_load_dwordx4 v[48:51], v5, s[20:23], 0 offen offset:256
    buffer_load_dwordx4 v[52:55], v5, s[20:23], 0 offen offset:320
    buffer_load_dwordx4 v[56:59], v5, s[20:23], 0 offen offset:384
    buffer_load_dwordx4 v[60:63], v5, s[20:23], 0 offen offset:448
    v_lshlrev_b32 v7, 4, v2
    v_add_u32 v7, s18, v7
    s_add_u32 s19, s18, 4096
    s_mov_b32 m0, s19
    s_nop 0
    buffer_load_dwordx4 v7, s[24:27], 0 offen offset:0 lds
    buffer_load_dwordx4 v7, s[24:27], 0 offen offset:1024 lds
    buffer_load_dwordx4 v7, s[24:27], 0 offen offset:2048 lds
    buffer_load_dwordx4 v7, s[24:27], 0 offen offset:3072 lds
    s_add_u32 s19, s18, 8192
    s_mov_b32 m0, s19
    v_add_u32 v7, 4096, v7
    buffer_load_dwordx4 v7, s[24:27], 0 offen offset:0 lds
    buffer_load_dwordx4 v7, s[24:27], 0 offen offset:1024 lds
    buffer_load_dwordx4 v7, s[24:27], 0 offen offset:2048 lds
    buffer_load_dwordx4 v7, s[24:27], 0 offen offset:3072 lds
    s_lshl_b32 s19, s15, 11
    v_lshlrev_b32 v8, 2, v0
    v_add_u32 v8, s19, v8
    s_mov_b32 s40, 0
    buffer_load_dword v10, v8, s[36:39], s40 offen
    s_mov_b32 s40, 16384
    buffer_load_dword v11, v8, s[36:39], s40 offen
    s_mov_b32 s40, 32768
    buffer_load_dword v12, v8, s[36:39], s40 offen
    s_mov_b32 s40, 49152
    buffer_load_dword v13, v8, s[36:39], s40 offen
    s_mov_b32 s40, 65536
    buffer_load_dword v14, v8, s[36:39], s40 offen
    s_mov_b32 s40, 81920
    buffer_load_dword v15, v8, s[36:39], s40 offen
    s_mov_b32 s40, 98304
    buffer_load_dword v16, v8, s[36:39], s40 offen
    s_mov_b32 s40, 114688
    buffer_load_dword v17, v8, s[36:39], s40 offen
    s_waitcnt vmcnt(0)
    v_add_f32 v10, v10, v11
    v_add_f32 v10, v10, v12
    v_add_f32 v10, v10, v13
    v_add_f32 v10, v10, v14
    v_add_f32 v10, v10, v15
    v_add_f32 v10, v10, v16
    v_add_f32 v10, v10, v17
    v_cvt_pk_bf16_f32 v10, v10, v10
    v_lshlrev_b32 v9, 1, v0
    ds_write_b16 v9, v10 offset:0
    s_waitcnt lgkmcnt(0)
    s_barrier
    v_and_b32 v9, 1, v2
    v_lshlrev_b32 v9, 9, v9
    v_add_u32 v9, v9, v6
    ds_read_b128 v[64:67], v9 offset:0
    ds_read_b128 v[68:71], v9 offset:64
    ds_read_b128 v[72:75], v9 offset:128
    ds_read_b128 v[76:79], v9 offset:192
    ds_read_b128 v[80:83], v9 offset:256
    ds_read_b128 v[84:87], v9 offset:320
    ds_read_b128 v[88:91], v9 offset:384
    ds_read_b128 v[92:95], v9 offset:448
    v_mov_b32 v96, 0
    v_mov_b32 v97, 0
    v_mov_b32 v98, 0
    v_mov_b32 v99, 0
    s_waitcnt lgkmcnt(0)
    s_nop 1
    v_mfma_f32_16x16x32_bf16 v[96:99], v[64:67], v[32:35], v[96:99]
    v_mfma_f32_16x16x32_bf16 v[96:99], v[68:71], v[36:39], v[96:99]
    v_mfma_f32_16x16x32_bf16 v[96:99], v[72:75], v[40:43], v[96:99]
    v_mfma_f32_16x16x32_bf16 v[96:99], v[76:79], v[44:47], v[96:99]
    v_mfma_f32_16x16x32_bf16 v[96:99], v[80:83], v[48:51], v[96:99]
    v_mfma_f32_16x16x32_bf16 v[96:99], v[84:87], v[52:55], v[96:99]
    v_mfma_f32_16x16x32_bf16 v[96:99], v[88:91], v[56:59], v[96:99]
    v_mfma_f32_16x16x32_bf16 v[96:99], v[92:95], v[60:63], v[96:99]
    s_nop 7
    s_nop 1
    v_cvt_pk_bf16_f32 v96, v96, v96
    v_lshlrev_b32 v96, 16, v96
    v_cvt_pk_bf16_f32 v97, v97, v97
    v_lshlrev_b32 v97, 16, v97
    v_mul_f32 v96, 0x3d800000, v96
    v_mul_f32 v97, 0x3d800000, v97
    s_lshl_b32 s19, s14, 6
    v_lshlrev_b32 v9, 2, v2
    v_add_u32 v9, s19, v9
    s_mov_b64 exec, 0xffff
    ds_write_b32 v9, v96 offset:1024
    ds_write_b32 v9, v97 offset:1536
    s_mov_b64 exec, -1
    s_waitcnt vmcnt(0) lgkmcnt(0)
    s_barrier
    v_lshlrev_b32 v9, 3, v2
    ds_read_b64 v[10:11], v9 offset:1024
    ds_read_b64 v[12:13], v9 offset:1536
    s_waitcnt lgkmcnt(0)
    v_max_f32 v14, v10, v11
    v_max_f32 v15, v12, v13
    s_nop 1
    v_max_f32_dpp v14, v14, v14 quad_perm:[1,0,3,2] row_mask:0xf bank_mask:0xf
    s_nop 1
    v_max_f32_dpp v14, v14, v14 quad_perm:[2,3,0,1] row_mask:0xf bank_mask:0xf
    s_nop 1
    v_max_f32_dpp v14, v14, v14 row_half_mirror row_mask:0xf bank_mask:0xf
    s_nop 1
    v_max_f32_dpp v14, v14, v14 row_mirror row_mask:0xf bank_mask:0xf
    s_nop 1
    v_readlane_b32 s40, v14, 0
    v_readlane_b32 s41, v14, 16
    v_readlane_b32 s42, v14, 32
    v_readlane_b32 s43, v14, 48
    s_nop 1
    v_mov_b32 v14, s40
    v_max_f32 v14, s41, v14
    v_max_f32 v14, s42, v14
    v_max_f32 v14, s43, v14
    s_nop 1
    v_max_f32_dpp v15, v15, v15 quad_perm:[1,0,3,2] row_mask:0xf bank_mask:0xf
    s_nop 1
    v_max_f32_dpp v15, v15, v15 quad_perm:[2,3,0,1] row_mask:0xf bank_mask:0xf
    s_nop 1
    v_max_f32_dpp v15, v15, v15 row_half_mirror row_mask:0xf bank_mask:0xf
    s_nop 1
    v_max_f32_dpp v15, v15, v15 row_mirror row_mask:0xf bank_mask:0xf
    s_nop 1
    v_readlane_b32 s40, v15, 0
    v_readlane_b32 s41, v15, 16
    v_readlane_b32 s42, v15, 32
    v_readlane_b32 s43, v15, 48
    s_nop 1
    v_mov_b32 v15, s40
    v_max_f32 v15, s41, v15
    v_max_f32 v15, s42, v15
    v_max_f32 v15, s43, v15
    v_sub_f32 v10, v10, v14
    v_mul_f32 v10, 0x3fb8aa3b, v10
    v_exp_f32 v10, v10
    v_sub_f32 v11, v11, v14
    v_mul_f32 v11, 0x3fb8aa3b, v11
    v_exp_f32 v11, v11
    v_sub_f32 v12, v12, v15
    v_mul_f32 v12, 0x3fb8aa3b, v12
    v_exp_f32 v12, v12
    v_sub_f32 v13, v13, v15
    v_mul_f32 v13, 0x3fb8aa3b, v13
    v_exp_f32 v13, v13
    s_nop 0
    v_add_f32 v16, v10, v11
    v_add_f32 v17, v12, v13
    s_nop 1
    v_add_f32_dpp v16, v16, v16 quad_perm:[1,0,3,2] row_mask:0xf bank_mask:0xf
    s_nop 1
    v_add_f32_dpp v16, v16, v16 quad_perm:[2,3,0,1] row_mask:0xf bank_mask:0xf
    s_nop 1
    v_add_f32_dpp v16, v16, v16 row_half_mirror row_mask:0xf bank_mask:0xf
    s_nop 1
    v_add_f32_dpp v16, v16, v16 row_mirror row_mask:0xf bank_mask:0xf
    s_nop 1
    v_readlane_b32 s40, v16, 0
    v_readlane_b32 s41, v16, 16
    v_readlane_b32 s42, v16, 32
    v_readlane_b32 s43, v16, 48
    s_nop 1
    v_mov_b32 v16, s40
    v_add_f32 v16, s41, v16
    v_add_f32 v16, s42, v16
    v_add_f32 v16, s43, v16
    s_nop 1
    v_add_f32_dpp v17, v17, v17 quad_perm:[1,0,3,2] row_mask:0xf bank_mask:0xf
    s_nop 1
    v_add_f32_dpp v17, v17, v17 quad_perm:[2,3,0,1] row_mask:0xf bank_mask:0xf
    s_nop 1
    v_add_f32_dpp v17, v17, v17 row_half_mirror row_mask:0xf bank_mask:0xf
    s_nop 1
    v_add_f32_dpp v17, v17, v17 row_mirror row_mask:0xf bank_mask:0xf
    s_nop 1
    v_readlane_b32 s40, v17, 0
    v_readlane_b32 s41, v17, 16
    v_readlane_b32 s42, v17, 32
    v_readlane_b32 s43, v17, 48
    s_nop 1
    v_mov_b32 v17, s40
    v_add_f32 v17, s41, v17
    v_add_f32 v17, s42, v17
    v_add_f32 v17, s43, v17
    v_cvt_pk_bf16_f32 v18, v10, v11
    v_cvt_pk_bf16_f32 v19, v12, v13
    v_lshlrev_b32 v9, 2, v2
    ds_write_b32 v9, v18 offset:2048
    ds_write_b32 v9, v19 offset:2304
    s_waitcnt lgkmcnt(0)
    v_and_b32 v9, 1, v2
    v_lshlrev_b32 v9, 8, v9
    v_add_u32 v9, v9, v6
    ds_read_b128 v[64:67], v9 offset:2048
    ds_read_b128 v[68:71], v9 offset:2112
    ds_read_b128 v[72:75], v9 offset:2176
    ds_read_b128 v[76:79], v9 offset:2240
    v_lshlrev_b32 v20, 12, v4
    v_lshrrev_b32 v21, 2, v3
    v_lshlrev_b32 v21, 9, v21
    v_and_b32 v22, 3, v3
    v_lshlrev_b32 v22, 3, v22
    v_add3_u32 v20, v20, v21, v22
    s_lshl_b32 s19, s14, 6
    v_add_u32 v20, s19, v20
    v_mov_b32 v100, 0
    v_mov_b32 v101, 0
    v_mov_b32 v102, 0
    v_mov_b32 v103, 0
    ds_read_b64_tr_b16 v[80:81], v20 offset:4096
    ds_read_b64_tr_b16 v[82:83], v20 offset:6144
    ds_read_b64_tr_b16 v[84:85], v20 offset:20480
    ds_read_b64_tr_b16 v[86:87], v20 offset:22528
    ds_read_b64_tr_b16 v[88:89], v20 offset:36864
    ds_read_b64_tr_b16 v[90:91], v20 offset:38912
    ds_read_b64_tr_b16 v[92:93], v20 offset:53248
    ds_read_b64_tr_b16 v[94:95], v20 offset:55296
    s_waitcnt lgkmcnt(0)
    v_mfma_f32_16x16x32_bf16 v[100:103], v[64:67], v[80:83], v[100:103]
    v_mfma_f32_16x16x32_bf16 v[100:103], v[68:71], v[84:87], v[100:103]
    v_mfma_f32_16x16x32_bf16 v[100:103], v[72:75], v[88:91], v[100:103]
    v_mfma_f32_16x16x32_bf16 v[100:103], v[76:79], v[92:95], v[100:103]
    s_nop 7
    s_nop 1
    s_lshl_b32 s40, s2, 11
    s_add_u32 s40, s40, 262144
    s_lshl_b32 s41, s14, 7
    s_add_u32 s40, s40, s41
    v_lshlrev_b32 v9, 2, v2
    s_mov_b64 exec, 0xffff
    buffer_store_dword v100, v9, s[36:39], s40 offen
    buffer_store_dword v101, v9, s[36:39], s40 offen offset:1024
    s_mov_b64 exec, -1
    v_mov_b32 v100, 0
    v_mov_b32 v101, 0
    v_mov_b32 v102, 0
    v_mov_b32 v103, 0
    ds_read_b64_tr_b16 v[80:81], v20 offset:4128
    ds_read_b64_tr_b16 v[82:83], v20 offset:6176
    ds_read_b64_tr_b16 v[84:85], v20 offset:20512
    ds_read_b64_tr_b16 v[86:87], v20 offset:22560
    ds_read_b64_tr_b16 v[88:89], v20 offset:36896
    ds_read_b64_tr_b16 v[90:91], v20 offset:38944
    ds_read_b64_tr_b16 v[92:93], v20 offset:53280
    ds_read_b64_tr_b16 v[94:95], v20 offset:55328
    s_waitcnt lgkmcnt(0)
    v_mfma_f32_16x16x32_bf16 v[100:103], v[64:67], v[80:83], v[100:103]
    v_mfma_f32_16x16x32_bf16 v[100:103], v[68:71], v[84:87], v[100:103]
    v_mfma_f32_16x16x32_bf16 v[100:103], v[72:75], v[88:91], v[100:103]
    v_mfma_f32_16x16x32_bf16 v[100:103], v[76:79], v[92:95], v[100:103]
    s_nop 7
    s_nop 1
    s_lshl_b32 s40, s2, 11
    s_add_u32 s40, s40, 262208
    s_lshl_b32 s41, s14, 7
    s_add_u32 s40, s40, s41
    v_lshlrev_b32 v9, 2, v2
    s_mov_b64 exec, 0xffff
    buffer_store_dword v100, v9, s[36:39], s40 offen
    buffer_store_dword v101, v9, s[36:39], s40 offen offset:1024
    s_mov_b64 exec, -1
    s_cmp_lg_u32 s14, 0
    s_cbranch_scc1 attn_end
    v_mov_b32 v24, v14
    v_mov_b32 v25, v15
    v_mov_b32 v26, v16
    v_mov_b32 v27, v17
    v_mov_b32 v9, 0
    s_lshl_b32 s40, s2, 4
    s_add_u32 s40, s40, 786432
    s_mov_b64 exec, 1
    buffer_store_dwordx4 v[24:27], v9, s[36:39], s40 offen
attn_end:
    s_endpgm
.globl outp_kernel
.p2align 8
.type outp_kernel,@function
outp_kernel:
    s_load_dwordx2 s[4:5], s[0:1], 32
    s_load_dwordx2 s[6:7], s[0:1], 64
    s_load_dwordx2 s[12:13], s[0:1], 88
    v_lshrrev_b32 v1, 6, v0
    v_and_b32 v2, 63, v0
    s_nop 0
    v_readfirstlane_b32 s14, v1
    s_cmp_ge_u32 s2, 256
    s_cbranch_scc1 outp_end
    s_lshr_b32 s15, s2, 4
    s_and_b32 s16, s2, 15
    s_lshr_b32 s17, s15, 1
    s_and_b32 s18, s15, 1
    s_waitcnt lgkmcnt(0)
    s_mov_b32 s20, s4
    s_mov_b32 s21, s5
    s_mov_b32 s22, 3670016
    s_mov_b32 s23, 0x00020000
    s_mov_b32 s24, s6
    s_mov_b32 s25, s7
    s_mov_b32 s26, 1605632
    s_mov_b32 s27, 0x00020000
    s_mov_b32 s36, s12
    s_mov_b32 s37, s13
    s_mov_b32 s38, 1073741824
    s_mov_b32 s39, 0x00020000
    s_lshl_b32 s19, s15, 8
    s_lshl_b32 s40, s16, 4
    s_add_u32 s19, s19, s40
    s_lshl_b32 s40, s14, 1
    s_add_u32 s19, s19, s40
    s_mul_i32 s19, s19, 896
    v_lshlrev_b32 v3, 4, v2
    v_cmp_gt_u32 vcc, 56, v2
    s_and_saveexec_b64 s[42:43], vcc
    buffer_load_dwordx4 v[32:35], v3, s[20:23], s19 offen
    buffer_load_dwordx4 v[36:39], v3, s[20:23], s19 offen offset:896
    s_mul_i32 s44, s2, 7
    s_add_u32 s44, s44, s14
    s_mul_i32 s45, s44, 896
    buffer_load_dwordx4 v[40:43], v3, s[24:27], s45 offen
    s_mov_b64 exec, s[42:43]
    s_lshl_b32 s46, s44, 2
    v_mov_b32 v4, 0
    s_add_u32 s47, s46, 131072
    buffer_load_dword v48, v4, s[36:39], s47 offen
    s_add_u32 s48, s47, 7168
    buffer_load_dword v56, v4, s[36:39], s48 offen
    s_add_u32 s47, s46, 145408
    buffer_load_dword v49, v4, s[36:39], s47 offen
    s_add_u32 s48, s47, 7168
    buffer_load_dword v57, v4, s[36:39], s48 offen
    s_add_u32 s47, s46, 159744
    buffer_load_dword v50, v4, s[36:39], s47 offen
    s_add_u32 s48, s47, 7168
    buffer_load_dword v58, v4, s[36:39], s48 offen
    s_add_u32 s47, s46, 174080
    buffer_load_dword v51, v4, s[36:39], s47 offen
    s_add_u32 s48, s47, 7168
    buffer_load_dword v59, v4, s[36:39], s48 offen
    s_add_u32 s47, s46, 188416
    buffer_load_dword v52, v4, s[36:39], s47 offen
    s_add_u32 s48, s47, 7168
    buffer_load_dword v60, v4, s[36:39], s48 offen
    s_add_u32 s47, s46, 202752
    buffer_load_dword v53, v4, s[36:39], s47 offen
    s_add_u32 s48, s47, 7168
    buffer_load_dword v61, v4, s[36:39], s48 offen
    s_add_u32 s47, s46, 217088
    buffer_load_dword v54, v4, s[36:39], s47 offen
    s_add_u32 s48, s47, 7168
    buffer_load_dword v62, v4, s[36:39], s48 offen
    s_add_u32 s47, s46, 231424
    buffer_load_dword v55, v4, s[36:39], s47 offen
    s_add_u32 s48, s47, 7168
    buffer_load_dword v63, v4, s[36:39], s48 offen
    s_lshl_b32 s47, s17, 9
    s_add_u32 s47, s47, 786432
    v_and_b32 v5, 31, v2
    v_lshlrev_b32 v5, 4, v5
    buffer_load_dwordx4 v[64:67], v5, s[36:39], s47 offen
    v_lshrrev_b32 v6, 4, v0
    v_and_b32 v7, 15, v0
    v_lshlrev_b32 v8, 11, v6
    v_lshlrev_b32 v9, 2, v7
    v_add_u32 v8, v8, v9
    s_lshl_b32 s47, s17, 16
    s_lshl_b32 s48, s18, 10
    s_add_u32 s47, s47, s48
    s_lshl_b32 s48, s16, 6
    s_add_u32 s47, s47, s48
    s_add_u32 s47, s47, 262144
    buffer_load_dword v68, v8, s[36:39], s47 offen
    v_lshlrev_b32 v9, 4, v6
    s_lshl_b32 s47, s17, 9
    s_add_u32 s47, s47, 786432
    buffer_load_dwordx4 v[72:75], v9, s[36:39], s47 offen
    s_waitcnt vmcnt(0)
    s_cmp_eq_u32 s18, 1
    s_cselect_b64 vcc, -1, 0
    v_cndmask_b32 v64, v64, v65, vcc
    v_cndmask_b32 v66, v66, v67, vcc
    v_cndmask_b32 v72, v72, v73, vcc
    v_mov_b32 v76, v64
    s_nop 1
    v_max_f32_dpp v76, v76, v76 quad_perm:[1,0,3,2] row_mask:0xf bank_mask:0xf
    s_nop 1
    v_max_f32_dpp v76, v76, v76 quad_perm:[2,3,0,1] row_mask:0xf bank_mask:0xf
    s_nop 1
    v_max_f32_dpp v76, v76, v76 row_half_mirror row_mask:0xf bank_mask:0xf
    s_nop 1
    v_max_f32_dpp v76, v76, v76 row_mirror row_mask:0xf bank_mask:0xf
    s_nop 1
    v_readlane_b32 s40, v76, 0
    v_readlane_b32 s41, v76, 16
    v_readlane_b32 s42, v76, 32
    v_readlane_b32 s43, v76, 48
    s_nop 1
    v_mov_b32 v76, s40
    v_max_f32 v76, s41, v76
    v_max_f32 v76, s42, v76
    v_max_f32 v76, s43, v76
    v_sub_f32 v64, v64, v76
    v_mul_f32 v64, 0x3fb8aa3b, v64
    v_exp_f32 v64, v64
    s_nop 0
    v_mul_f32 v64, v64, v66
    v_cmp_gt_u32 vcc, 32, v2
    s_nop 1
    v_cndmask_b32 v64, 0, v64, vcc
    s_nop 1
    v_add_f32_dpp v64, v64, v64 quad_perm:[1,0,3,2] row_mask:0xf bank_mask:0xf
    s_nop 1
    v_add_f32_dpp v64, v64, v64 quad_perm:[2,3,0,1] row_mask:0xf bank_mask:0xf
    s_nop 1
    v_add_f32_dpp v64, v64, v64 row_half_mirror row_mask:0xf bank_mask:0xf
    s_nop 1
    v_add_f32_dpp v64, v64, v64 row_mirror row_mask:0xf bank_mask:0xf
    s_nop 1
    v_readlane_b32 s40, v64, 0
    v_readlane_b32 s41, v64, 16
    v_readlane_b32 s42, v64, 32
    v_readlane_b32 s43, v64, 48
    s_nop 1
    v_mov_b32 v64, s40
    v_add_f32 v64, s41, v64
    v_add_f32 v64, s42, v64
    v_add_f32 v64, s43, v64
    v_rcp_f32 v64, v64
    v_sub_f32 v72, v72, v76
    v_mul_f32 v72, 0x3fb8aa3b, v72
    v_exp_f32 v72, v72
    s_nop 0
    v_mul_f32 v68, v68, v72
    v_mul_f32 v68, v68, v64
    v_lshlrev_b32 v9, 2, v0
    ds_write_b32 v9, v68 offset:0
    s_waitcnt lgkmcnt(0)
    s_barrier
    v_and_b32 v9, 31, v2
    v_lshlrev_b32 v9, 6, v9
    s_lshl_b32 s47, s14, 3
    v_add_u32 v9, s47, v9
    ds_read_b64 v[70:71], v9 offset:0
    s_waitcnt lgkmcnt(0)
    v_cmp_gt_u32 vcc, 32, v2
    s_nop 1
    v_cndmask_b32 v70, 0, v70, vcc
    v_cndmask_b32 v71, 0, v71, vcc
    s_nop 1
    v_add_f32_dpp v70, v70, v70 quad_perm:[1,0,3,2] row_mask:0xf bank_mask:0xf
    s_nop 1
    v_add_f32_dpp v70, v70, v70 quad_perm:[2,3,0,1] row_mask:0xf bank_mask:0xf
    s_nop 1
    v_add_f32_dpp v70, v70, v70 row_half_mirror row_mask:0xf bank_mask:0xf
    s_nop 1
    v_add_f32_dpp v70, v70, v70 row_mirror row_mask:0xf bank_mask:0xf
    s_nop 1
    v_readlane_b32 s40, v70, 0
    v_readlane_b32 s41, v70, 16
    v_readlane_b32 s42, v70, 32
    v_readlane_b32 s43, v70, 48
    s_nop 1
    v_mov_b32 v70, s40
    v_add_f32 v70, s41, v70
    v_add_f32 v70, s42, v70
    v_add_f32 v70, s43, v70
    s_nop 1
    v_add_f32_dpp v71, v71, v71 quad_perm:[1,0,3,2] row_mask:0xf bank_mask:0xf
    s_nop 1
    v_add_f32_dpp v71, v71, v71 quad_perm:[2,3,0,1] row_mask:0xf bank_mask:0xf
    s_nop 1
    v_add_f32_dpp v71, v71, v71 row_half_mirror row_mask:0xf bank_mask:0xf
    s_nop 1
    v_add_f32_dpp v71, v71, v71 row_mirror row_mask:0xf bank_mask:0xf
    s_nop 1
    v_readlane_b32 s40, v71, 0
    v_readlane_b32 s41, v71, 16
    v_readlane_b32 s42, v71, 32
    v_readlane_b32 s43, v71, 48
    s_nop 1
    v_mov_b32 v71, s40
    v_add_f32 v71, s41, v71
    v_add_f32 v71, s42, v71
    v_add_f32 v71, s43, v71
    v_cvt_pk_bf16_f32 v70, v70, v70
    v_lshlrev_b32 v70, 16, v70
    v_cvt_pk_bf16_f32 v71, v71, v71
    v_lshlrev_b32 v71, 16, v71
    v_lshlrev_b32 v80, 16, v32
    v_and_b32 v81, 0xffff0000, v32
    v_mul_f32 v84, v80, v70
    v_mul_f32 v85, v81, v70
    v_lshlrev_b32 v80, 16, v36
    v_and_b32 v81, 0xffff0000, v36
    v_fmac_f32 v84, v80, v71
    v_fmac_f32 v85, v81, v71
    v_lshlrev_b32 v80, 16, v33
    v_and_b32 v81, 0xffff0000, v33
    v_mul_f32 v86, v80, v70
    v_mul_f32 v87, v81, v70
    v_lshlrev_b32 v80, 16, v37
    v_and_b32 v81, 0xffff0000, v37
    v_fmac_f32 v86, v80, v71
    v_fmac_f32 v87, v81, v71
    v_lshlrev_b32 v80, 16, v34
    v_and_b32 v81, 0xffff0000, v34
    v_mul_f32 v88, v80, v70
    v_mul_f32 v89, v81, v70
    v_lshlrev_b32 v80, 16, v38
    v_and_b32 v81, 0xffff0000, v38
    v_fmac_f32 v88, v80, v71
    v_fmac_f32 v89, v81, v71
    v_lshlrev_b32 v80, 16, v35
    v_and_b32 v81, 0xffff0000, v35
    v_mul_f32 v90, v80, v70
    v_mul_f32 v91, v81, v70
    v_lshlrev_b32 v80, 16, v39
    v_and_b32 v81, 0xffff0000, v39
    v_fmac_f32 v90, v80, v71
    v_fmac_f32 v91, v81, v71
    v_add_f32 v48, v48, v49
    v_add_f32 v56, v56, v57
    v_add_f32 v48, v48, v50
    v_add_f32 v56, v56, v58
    v_add_f32 v48, v48, v51
    v_add_f32 v56, v56, v59
    v_add_f32 v48, v48, v52
    v_add_f32 v56, v56, v60
    v_add_f32 v48, v48, v53
    v_add_f32 v56, v56, v61
    v_add_f32 v48, v48, v54
    v_add_f32 v56, v56, v62
    v_add_f32 v48, v48, v55
    v_add_f32 v56, v56, v63
    v_cvt_pk_bf16_f32 v48, v48, v48
    v_lshlrev_b32 v48, 16, v48
    v_cvt_pk_bf16_f32 v56, v56, v56
    v_lshlrev_b32 v56, 16, v56
    v_mul_f32 v49, 0xbfb8aa3b, v48
    v_exp_f32 v49, v49
    s_nop 0
    v_add_f32 v49, 1.0, v49
    v_rcp_f32 v49, v49
    s_nop 0
    v_cvt_pk_bf16_f32 v49, v49, v49
    v_lshlrev_b32 v49, 16, v49
    v_mul_f32 v49, v49, v56
    v_cvt_pk_bf16_f32 v49, v49, v49
    v_lshlrev_b32 v49, 16, v49
    v_lshlrev_b32 v80, 16, v40
    v_and_b32 v81, 0xffff0000, v40
    v_mul_f32 v92, v80, v49
    v_mul_f32 v93, v81, v49
    v_lshlrev_b32 v80, 16, v41
    v_and_b32 v81, 0xffff0000, v41
    v_mul_f32 v94, v80, v49
    v_mul_f32 v95, v81, v49
    v_lshlrev_b32 v80, 16, v42
    v_and_b32 v81, 0xffff0000, v42
    v_mul_f32 v96, v80, v49
    v_mul_f32 v97, v81, v49
    v_lshlrev_b32 v80, 16, v43
    v_and_b32 v81, 0xffff0000, v43
    v_mul_f32 v98, v80, v49
    v_mul_f32 v99, v81, v49
    s_mul_i32 s47, s14, 1792
    v_lshlrev_b32 v9, 5, v2
    v_add_u32 v9, s47, v9
    v_cmp_gt_u32 vcc, 56, v2
    s_and_saveexec_b64 s[42:43], vcc
    ds_write_b128 v9, v[84:87] offset:2048
    ds_write_b128 v9, v[88:91] offset:2064
    s_cmp_ge_u32 s14, 7
    s_cbranch_scc1 outp_skipb
    ds_write_b128 v9, v[92:95] offset:16384
    ds_write_b128 v9, v[96:99] offset:16400
outp_skipb:
    s_mov_b64 exec, s[42:43]
    s_waitcnt lgkmcnt(0)
    s_barrier
    v_cmp_gt_u32 vcc, 448, v0
    s_and_saveexec_b64 s[42:43], vcc
    s_cbranch_execz outp_end
    v_lshlrev_b32 v9, 2, v0
    ds_read_b32 v100, v9 offset:2048
    ds_read_b32 v101, v9 offset:3840
    ds_read_b32 v102, v9 offset:5632
    ds_read_b32 v103, v9 offset:7424
    ds_read_b32 v104, v9 offset:9216
    ds_read_b32 v105, v9 offset:11008
    ds_read_b32 v106, v9 offset:12800
    ds_read_b32 v107, v9 offset:14592
    ds_read_b32 v108, v9 offset:16384
    ds_read_b32 v109, v9 offset:18176
    ds_read_b32 v110, v9 offset:19968
    ds_read_b32 v111, v9 offset:21760
    ds_read_b32 v112, v9 offset:23552
    ds_read_b32 v113, v9 offset:25344
    ds_read_b32 v114, v9 offset:27136
    s_waitcnt lgkmcnt(0)
    v_add_f32 v100, v100, v101
    v_add_f32 v100, v100, v102
    v_add_f32 v100, v100, v103
    v_add_f32 v100, v100, v104
    v_add_f32 v100, v100, v105
    v_add_f32 v100, v100, v106
    v_add_f32 v100, v100, v107
    v_add_f32 v108, v108, v109
    v_add_f32 v108, v108, v110
    v_add_f32 v108, v108, v111
    v_add_f32 v108, v108, v112
    v_add_f32 v108, v108, v113
    v_add_f32 v108, v108, v114
    s_mul_i32 s47, s2, 3584
    s_add_u32 s47, s47, 1048576
    buffer_store_dword v100, v9, s[36:39], s47 offen
    buffer_store_dword v108, v9, s[36:39], s47 offen offset:1792
outp_end:
    s_endpgm
.globl final_kernel
.p2align 8
.type final_kernel,@function
final_kernel:
    s_load_dwordx2 s[4:5], s[0:1], 0
    s_load_dwordx2 s[6:7], s[0:1], 72
    s_load_dwordx2 s[12:13], s[0:1], 88
    v_lshrrev_b32 v1, 6, v0
    v_and_b32 v2, 63, v0
    s_nop 0
    v_readfirstlane_b32 s14, v1
    s_cmp_ge_u32 s2, 7
    s_cbranch_scc1 final_end
    s_waitcnt lgkmcnt(0)
    s_mov_b32 s20, s4
    s_mov_b32 s21, s5
    s_mov_b32 s22, 896
    s_mov_b32 s23, 0x00020000
    s_mov_b32 s24, s6
    s_mov_b32 s25, s7
    s_mov_b32 s26, 896
    s_mov_b32 s27, 0x00020000
    s_mov_b32 s36, s12
    s_mov_b32 s37, s13
    s_mov_b32 s38, 1073741824
    s_mov_b32 s39, 0x00020000
    s_lshl_b32 s15, s2, 6
    v_add_u32 v3, s15, v2
    v_lshlrev_b32 v4, 2, v3
    s_mul_i32 s16, s14, 57344
    s_add_u32 s16, s16, 1048576
    buffer_load_dword v10, v4, s[36:39], s16 offen
    buffer_load_dword v11, v4, s[36:39], s16 offen offset:1792
    s_add_u32 s16, s16, 3584
    buffer_load_dword v12, v4, s[36:39], s16 offen
    buffer_load_dword v13, v4, s[36:39], s16 offen offset:1792
    s_add_u32 s16, s16, 3584
    buffer_load_dword v14, v4, s[36:39], s16 offen
    buffer_load_dword v15, v4, s[36:39], s16 offen offset:1792
    s_add_u32 s16, s16, 3584
    buffer_load_dword v16, v4, s[36:39], s16 offen
    buffer_load_dword v17, v4, s[36:39], s16 offen offset:1792
    s_add_u32 s16, s16, 3584
    buffer_load_dword v18, v4, s[36:39], s16 offen
    buffer_load_dword v19, v4, s[36:39], s16 offen offset:1792
    s_add_u32 s16, s16, 3584
    buffer_load_dword v20, v4, s[36:39], s16 offen
    buffer_load_dword v21, v4, s[36:39], s16 offen offset:1792
    s_add_u32 s16, s16, 3584
    buffer_load_dword v22, v4, s[36:39], s16 offen
    buffer_load_dword v23, v4, s[36:39], s16 offen offset:1792
    s_add_u32 s16, s16, 3584
    buffer_load_dword v24, v4, s[36:39], s16 offen
    buffer_load_dword v25, v4, s[36:39], s16 offen offset:1792
    s_add_u32 s16, s16, 3584
    buffer_load_dword v26, v4, s[36:39], s16 offen
    buffer_load_dword v27, v4, s[36:39], s16 offen offset:1792
    s_add_u32 s16, s16, 3584
    buffer_load_dword v28, v4, s[36:39], s16 offen
    buffer_load_dword v29, v4, s[36:39], s16 offen offset:1792
    s_add_u32 s16, s16, 3584
    buffer_load_dword v30, v4, s[36:39], s16 offen
    buffer_load_dword v31, v4, s[36:39], s16 offen offset:1792
    s_add_u32 s16, s16, 3584
    buffer_load_dword v32, v4, s[36:39], s16 offen
    buffer_load_dword v33, v4, s[36:39], s16 offen offset:1792
    s_add_u32 s16, s16, 3584
    buffer_load_dword v34, v4, s[36:39], s16 offen
    buffer_load_dword v35, v4, s[36:39], s16 offen offset:1792
    s_add_u32 s16, s16, 3584
    buffer_load_dword v36, v4, s[36:39], s16 offen
    buffer_load_dword v37, v4, s[36:39], s16 offen offset:1792
    s_add_u32 s16, s16, 3584
    buffer_load_dword v38, v4, s[36:39], s16 offen
    buffer_load_dword v39, v4, s[36:39], s16 offen offset:1792
    s_add_u32 s16, s16, 3584
    buffer_load_dword v40, v4, s[36:39], s16 offen
    buffer_load_dword v41, v4, s[36:39], s16 offen offset:1792
    s_add_u32 s16, s16, 3584
    s_waitcnt vmcnt(0)
    v_add_f32 v10, v10, v12
    v_add_f32 v11, v11, v13
    v_add_f32 v10, v10, v14
    v_add_f32 v11, v11, v15
    v_add_f32 v10, v10, v16
    v_add_f32 v11, v11, v17
    v_add_f32 v10, v10, v18
    v_add_f32 v11, v11, v19
    v_add_f32 v10, v10, v20
    v_add_f32 v11, v11, v21
    v_add_f32 v10, v10, v22
    v_add_f32 v11, v11, v23
    v_add_f32 v10, v10, v24
    v_add_f32 v11, v11, v25
    v_add_f32 v10, v10, v26
    v_add_f32 v11, v11, v27
    v_add_f32 v10, v10, v28
    v_add_f32 v11, v11, v29
    v_add_f32 v10, v10, v30
    v_add_f32 v11, v11, v31
    v_add_f32 v10, v10, v32
    v_add_f32 v11, v11, v33
    v_add_f32 v10, v10, v34
    v_add_f32 v11, v11, v35
    v_add_f32 v10, v10, v36
    v_add_f32 v11, v11, v37
    v_add_f32 v10, v10, v38
    v_add_f32 v11, v11, v39
    v_add_f32 v10, v10, v40
    v_add_f32 v11, v11, v41
    v_lshlrev_b32 v5, 3, v0
    ds_write_b64 v5, v[10:11]
    s_waitcnt lgkmcnt(0)
    s_barrier
    s_cmp_lg_u32 s14, 0
    s_cbranch_scc1 final_end
    v_lshlrev_b32 v5, 3, v2
    ds_read_b64 v[10:11], v5 offset:0
    ds_read_b64 v[12:13], v5 offset:512
    ds_read_b64 v[14:15], v5 offset:1024
    ds_read_b64 v[16:17], v5 offset:1536
    ds_read_b64 v[18:19], v5 offset:2048
    ds_read_b64 v[20:21], v5 offset:2560
    ds_read_b64 v[22:23], v5 offset:3072
    ds_read_b64 v[24:25], v5 offset:3584
    ds_read_b64 v[26:27], v5 offset:4096
    ds_read_b64 v[28:29], v5 offset:4608
    ds_read_b64 v[30:31], v5 offset:5120
    ds_read_b64 v[32:33], v5 offset:5632
    ds_read_b64 v[34:35], v5 offset:6144
    ds_read_b64 v[36:37], v5 offset:6656
    ds_read_b64 v[38:39], v5 offset:7168
    ds_read_b64 v[40:41], v5 offset:7680
    v_lshlrev_b32 v6, 1, v3
    buffer_load_ushort v50, v6, s[20:23], 0 offen
    s_waitcnt lgkmcnt(0)
    v_add_f32 v10, v10, v12
    v_add_f32 v11, v11, v13
    v_add_f32 v10, v10, v14
    v_add_f32 v11, v11, v15
    v_add_f32 v10, v10, v16
    v_add_f32 v11, v11, v17
    v_add_f32 v10, v10, v18
    v_add_f32 v11, v11, v19
    v_add_f32 v10, v10, v20
    v_add_f32 v11, v11, v21
    v_add_f32 v10, v10, v22
    v_add_f32 v11, v11, v23
    v_add_f32 v10, v10, v24
    v_add_f32 v11, v11, v25
    v_add_f32 v10, v10, v26
    v_add_f32 v11, v11, v27
    v_add_f32 v10, v10, v28
    v_add_f32 v11, v11, v29
    v_add_f32 v10, v10, v30
    v_add_f32 v11, v11, v31
    v_add_f32 v10, v10, v32
    v_add_f32 v11, v11, v33
    v_add_f32 v10, v10, v34
    v_add_f32 v11, v11, v35
    v_add_f32 v10, v10, v36
    v_add_f32 v11, v11, v37
    v_add_f32 v10, v10, v38
    v_add_f32 v11, v11, v39
    v_add_f32 v10, v10, v40
    v_add_f32 v11, v11, v41
    v_cvt_pk_bf16_f32 v10, v10, v10
    v_lshlrev_b32 v10, 16, v10
    v_cvt_pk_bf16_f32 v11, v11, v11
    v_lshlrev_b32 v11, 16, v11
    s_waitcnt vmcnt(0)
    v_lshlrev_b32 v50, 16, v50
    v_add_f32 v50, v50, v10
    v_cvt_pk_bf16_f32 v50, v50, v50
    v_lshlrev_b32 v50, 16, v50
    v_add_f32 v50, v50, v11
    v_cvt_pk_bf16_f32 v50, v50, v50
    buffer_store_short v50, v6, s[24:27], 0 offen
final_end:
    s_endpgm
.section .rodata,"a"
.p2align 6
.amdhsa_kernel proj_kernel
  .amdhsa_next_free_vgpr 128
  .amdhsa_next_free_sgpr 96
  .amdhsa_accum_offset 128
  .amdhsa_group_segment_fixed_size 0
  .amdhsa_kernarg_size 96
  .amdhsa_user_sgpr_count 2
  .amdhsa_user_sgpr_kernarg_segment_ptr 1
  .amdhsa_system_sgpr_workgroup_id_x 1
.end_amdhsa_kernel
.p2align 6
.amdhsa_kernel attn_kernel
  .amdhsa_next_free_vgpr 128
  .amdhsa_next_free_sgpr 96
  .amdhsa_accum_offset 128
  .amdhsa_group_segment_fixed_size 0
  .amdhsa_kernarg_size 96
  .amdhsa_user_sgpr_count 2
  .amdhsa_user_sgpr_kernarg_segment_ptr 1
  .amdhsa_system_sgpr_workgroup_id_x 1
.end_amdhsa_kernel
.p2align 6
.amdhsa_kernel outp_kernel
  .amdhsa_next_free_vgpr 128
  .amdhsa_next_free_sgpr 96
  .amdhsa_accum_offset 128
  .amdhsa_group_segment_fixed_size 0
  .amdhsa_kernarg_size 96
  .amdhsa_user_sgpr_count 2
  .amdhsa_user_sgpr_kernarg_segment_ptr 1
  .amdhsa_system_sgpr_workgroup_id_x 1
.end_amdhsa_kernel
.p2align 6
.amdhsa_kernel final_kernel
  .amdhsa_next_free_vgpr 128
  .amdhsa_next_free_sgpr 96
  .amdhsa_accum_offset 128
  .amdhsa_group_segment_fixed_size 0
  .amdhsa_kernarg_size 96
  .amdhsa_user_sgpr_count 2
  .amdhsa_user_sgpr_kernarg_segment_ptr 1
  .amdhsa_system_sgpr_workgroup_id_x 1
.end_amdhsa_kernel
```

```asm
; @launch kernel=proj_kernel grid=(240,1,1) block=(256,1,1) lds=8192
; @launch kernel=attn_kernel grid=(256,1,1) block=(512,1,1) lds=69632
; @launch kernel=outp_kernel grid=(256,1,1) block=(512,1,1) lds=32768
; @launch kernel=final_kernel grid=(7,1,1) block=(1024,1,1) lds=8192
.amdgcn_target "amdgcn-amd-amdhsa--gfx950"
.text
.globl proj_kernel
.p2align 8
.type proj_kernel,@function
proj_kernel:
    s_load_dwordx2 s[4:5], s[0:1], 0
    s_load_dwordx2 s[6:7], s[0:1], 24
    s_load_dwordx2 s[8:9], s[0:1], 48
    s_load_dwordx2 s[10:11], s[0:1], 56
    s_load_dwordx2 s[12:13], s[0:1], 88
    v_lshrrev_b32 v1, 6, v0
    v_and_b32 v2, 63, v0
    s_nop 0
    v_readfirstlane_b32 s14, v1
    s_cmp_ge_u32 s2, 240
    s_cbranch_scc1 proj_end
    s_lshl_b32 s15, s2, 2
    s_add_u32 s15, s15, s14
    s_lshr_b32 s16, s15, 3
    s_and_b32 s17, s15, 7
    s_waitcnt lgkmcnt(0)
    s_cmp_lt_u32 s16, 64
    s_cbranch_scc0 proj_notq
    s_mov_b32 s18, s6
    s_mov_b32 s19, s7
    s_mov_b32 s20, 8192
    s_lshl_b32 s21, s16, 7
    s_lshl_b32 s22, s17, 14
    s_lshl_b32 s24, s16, 8
    s_add_u32 s22, s22, s24
    s_add_u32 s22, s22, 0
    s_mov_b32 s23, 3670016
    s_branch proj_sel_done
proj_notq:
    s_mov_b32 s20, 3584
    s_mov_b32 s23, 1605632
    s_sub_u32 s24, s16, 64
    s_mul_i32 s22, s17, 14336
    s_lshl_b32 s25, s24, 8
    s_add_u32 s22, s22, s25
    s_add_u32 s22, s22, 131072
    s_cmp_lt_u32 s16, 92
    s_cbranch_scc0 proj_up
    s_mov_b32 s18, s8
    s_mov_b32 s19, s9
    s_lshl_b32 s21, s24, 7
    s_branch proj_sel_done
proj_up:
    s_mov_b32 s18, s10
    s_mov_b32 s19, s11
    s_sub_u32 s25, s16, 92
    s_lshl_b32 s21, s25, 7
proj_sel_done:
    s_mov_b32 s28, s18
    s_mov_b32 s29, s19
    s_mov_b32 s30, s23
    s_mov_b32 s31, 0x00020000
    s_mov_b32 s32, s4
    s_mov_b32 s33, s5
    s_mov_b32 s34, 896
    s_mov_b32 s35, 0x00020000
    s_mov_b32 s36, s12
    s_mov_b32 s37, s13
    s_mov_b32 s38, 1073741824
    s_mov_b32 s39, 0x00020000
    v_lshlrev_b32 v3, 1, v2
    buffer_load_ushort v10, v3, s[32:35], 0 offen offset:0
    buffer_load_ushort v11, v3, s[32:35], 0 offen offset:128
    buffer_load_ushort v12, v3, s[32:35], 0 offen offset:256
    buffer_load_ushort v13, v3, s[32:35], 0 offen offset:384
    buffer_load_ushort v14, v3, s[32:35], 0 offen offset:512
    buffer_load_ushort v15, v3, s[32:35], 0 offen offset:640
    buffer_load_ushort v16, v3, s[32:35], 0 offen offset:768
    v_lshrrev_b32 v4, 3, v2
    s_mul_i32 s24, s17, 56
    v_add_u32 v5, s24, v4
    v_lshlrev_b32 v5, 1, v5
    buffer_load_ushort v20, v5, s[32:35], 0 offen offset:0
    buffer_load_ushort v21, v5, s[32:35], 0 offen offset:16
    buffer_load_ushort v22, v5, s[32:35], 0 offen offset:32
    buffer_load_ushort v23, v5, s[32:35], 0 offen offset:48
    buffer_load_ushort v24, v5, s[32:35], 0 offen offset:64
    buffer_load_ushort v25, v5, s[32:35], 0 offen offset:80
    buffer_load_ushort v26, v5, s[32:35], 0 offen offset:96
    v_mul_lo_u32 v6, v4, s20
    v_and_b32 v7, 7, v2
    v_lshlrev_b32 v7, 4, v7
    v_add_u32 v6, v6, v7
    s_mul_i32 s24, s24, s20
    s_add_u32 s24, s24, s21
    s_lshl_b32 s25, s20, 3
    buffer_load_dwordx4 v[32:35], v6, s[28:31], s24 offen nt
    s_add_u32 s24, s24, s25
    buffer_load_dwordx4 v[36:39], v6, s[28:31], s24 offen nt
    s_add_u32 s24, s24, s25
    buffer_load_dwordx4 v[40:43], v6, s[28:31], s24 offen nt
    s_add_u32 s24, s24, s25
    buffer_load_dwordx4 v[44:47], v6, s[28:31], s24 offen nt
    s_add_u32 s24, s24, s25
    buffer_load_dwordx4 v[48:51], v6, s[28:31], s24 offen nt
    s_add_u32 s24, s24, s25
    buffer_load_dwordx4 v[52:55], v6, s[28:31], s24 offen nt
    s_add_u32 s24, s24, s25
    buffer_load_dwordx4 v[56:59], v6, s[28:31], s24 offen nt
    s_waitcnt vmcnt(14)
    v_lshlrev_b32 v10, 16, v10
    v_lshlrev_b32 v11, 16, v11
    v_lshlrev_b32 v12, 16, v12
    v_lshlrev_b32 v13, 16, v13
    v_lshlrev_b32 v14, 16, v14
    v_lshlrev_b32 v15, 16, v15
    v_lshlrev_b32 v16, 16, v16
    v_add_f32 v8, v10, v11
    v_add_f32 v8, v8, v12
    v_add_f32 v8, v8, v13
    v_add_f32 v8, v8, v14
    v_add_f32 v8, v8, v15
    v_add_f32 v8, v8, v16
    s_nop 1
    v_add_f32_dpp v8, v8, v8 quad_perm:[1,0,3,2] row_mask:0xf bank_mask:0xf
    s_nop 1
    v_add_f32_dpp v8, v8, v8 quad_perm:[2,3,0,1] row_mask:0xf bank_mask:0xf
    s_nop 1
    v_add_f32_dpp v8, v8, v8 row_half_mirror row_mask:0xf bank_mask:0xf
    s_nop 1
    v_add_f32_dpp v8, v8, v8 row_mirror row_mask:0xf bank_mask:0xf
    s_nop 1
    v_readlane_b32 s40, v8, 0
    v_readlane_b32 s41, v8, 16
    v_readlane_b32 s42, v8, 32
    v_readlane_b32 s43, v8, 48
    s_nop 1
    v_mov_b32 v8, s40
    v_add_f32 v8, s41, v8
    v_add_f32 v8, s42, v8
    v_add_f32 v8, s43, v8
    v_mul_f32 v8, 0x3b124925, v8
    v_sub_f32 v9, v10, v8
    v_mul_f32 v9, v9, v9
    v_sub_f32 v17, v11, v8
    v_fmac_f32 v9, v17, v17
    v_sub_f32 v17, v12, v8
    v_fmac_f32 v9, v17, v17
    v_sub_f32 v17, v13, v8
    v_fmac_f32 v9, v17, v17
    v_sub_f32 v17, v14, v8
    v_fmac_f32 v9, v17, v17
    v_sub_f32 v17, v15, v8
    v_fmac_f32 v9, v17, v17
    v_sub_f32 v17, v16, v8
    v_fmac_f32 v9, v17, v17
    s_nop 1
    v_add_f32_dpp v9, v9, v9 quad_perm:[1,0,3,2] row_mask:0xf bank_mask:0xf
    s_nop 1
    v_add_f32_dpp v9, v9, v9 quad_perm:[2,3,0,1] row_mask:0xf bank_mask:0xf
    s_nop 1
    v_add_f32_dpp v9, v9, v9 row_half_mirror row_mask:0xf bank_mask:0xf
    s_nop 1
    v_add_f32_dpp v9, v9, v9 row_mirror row_mask:0xf bank_mask:0xf
    s_nop 1
    v_readlane_b32 s40, v9, 0
    v_readlane_b32 s41, v9, 16
    v_readlane_b32 s42, v9, 32
    v_readlane_b32 s43, v9, 48
    s_nop 1
    v_mov_b32 v9, s40
    v_add_f32 v9, s41, v9
    v_add_f32 v9, s42, v9
    v_add_f32 v9, s43, v9
    v_mul_f32 v9, 0x3b124925, v9
    v_cvt_pk_bf16_f32 v8, v8, v8
    v_lshlrev_b32 v8, 16, v8
    v_cvt_pk_bf16_f32 v9, v9, v9
    v_lshlrev_b32 v9, 16, v9
    v_add_f32 v9, 0x3727c5ac, v9
    v_cvt_pk_bf16_f32 v9, v9, v9
    v_lshlrev_b32 v9, 16, v9
    v_sqrt_f32 v9, v9
    s_nop 0
    v_cvt_pk_bf16_f32 v9, v9, v9
    v_lshlrev_b32 v9, 16, v9
    v_rcp_f32 v9, v9
    s_waitcnt vmcnt(7)
    v_lshlrev_b32 v20, 16, v20
    v_sub_f32 v20, v20, v8
    v_cvt_pk_bf16_f32 v20, v20, v20
    v_lshlrev_b32 v20, 16, v20
    v_mul_f32 v20, v20, v9
    v_cvt_pk_bf16_f32 v20, v20, v20
    v_lshlrev_b32 v20, 16, v20
    v_lshlrev_b32 v21, 16, v21
    v_sub_f32 v21, v21, v8
    v_cvt_pk_bf16_f32 v21, v21, v21
    v_lshlrev_b32 v21, 16, v21
    v_mul_f32 v21, v21, v9
    v_cvt_pk_bf16_f32 v21, v21, v21
    v_lshlrev_b32 v21, 16, v21
    v_lshlrev_b32 v22, 16, v22
    v_sub_f32 v22, v22, v8
    v_cvt_pk_bf16_f32 v22, v22, v22
    v_lshlrev_b32 v22, 16, v22
    v_mul_f32 v22, v22, v9
    v_cvt_pk_bf16_f32 v22, v22, v22
    v_lshlrev_b32 v22, 16, v22
    v_lshlrev_b32 v23, 16, v23
    v_sub_f32 v23, v23, v8
    v_cvt_pk_bf16_f32 v23, v23, v23
    v_lshlrev_b32 v23, 16, v23
    v_mul_f32 v23, v23, v9
    v_cvt_pk_bf16_f32 v23, v23, v23
    v_lshlrev_b32 v23, 16, v23
    v_lshlrev_b32 v24, 16, v24
    v_sub_f32 v24, v24, v8
    v_cvt_pk_bf16_f32 v24, v24, v24
    v_lshlrev_b32 v24, 16, v24
    v_mul_f32 v24, v24, v9
    v_cvt_pk_bf16_f32 v24, v24, v24
    v_lshlrev_b32 v24, 16, v24
    v_lshlrev_b32 v25, 16, v25
    v_sub_f32 v25, v25, v8
    v_cvt_pk_bf16_f32 v25, v25, v25
    v_lshlrev_b32 v25, 16, v25
    v_mul_f32 v25, v25, v9
    v_cvt_pk_bf16_f32 v25, v25, v25
    v_lshlrev_b32 v25, 16, v25
    v_lshlrev_b32 v26, 16, v26
    v_sub_f32 v26, v26, v8
    v_cvt_pk_bf16_f32 v26, v26, v26
    v_lshlrev_b32 v26, 16, v26
    v_mul_f32 v26, v26, v9
    v_cvt_pk_bf16_f32 v26, v26, v26
    v_lshlrev_b32 v26, 16, v26
    v_mov_b32 v64, 0
    v_mov_b32 v65, 0
    v_mov_b32 v66, 0
    v_mov_b32 v67, 0
    v_mov_b32 v68, 0
    v_mov_b32 v69, 0
    v_mov_b32 v70, 0
    v_mov_b32 v71, 0
    s_waitcnt vmcnt(6)
    v_lshlrev_b32 v72, 16, v32
    v_and_b32 v73, 0xffff0000, v32
    v_fmac_f32 v64, v72, v20
    v_fmac_f32 v65, v73, v20
    v_lshlrev_b32 v72, 16, v33
    v_and_b32 v73, 0xffff0000, v33
    v_fmac_f32 v66, v72, v20
    v_fmac_f32 v67, v73, v20
    v_lshlrev_b32 v72, 16, v34
    v_and_b32 v73, 0xffff0000, v34
    v_fmac_f32 v68, v72, v20
    v_fmac_f32 v69, v73, v20
    v_lshlrev_b32 v72, 16, v35
    v_and_b32 v73, 0xffff0000, v35
    v_fmac_f32 v70, v72, v20
    v_fmac_f32 v71, v73, v20
    s_waitcnt vmcnt(5)
    v_lshlrev_b32 v72, 16, v36
    v_and_b32 v73, 0xffff0000, v36
    v_fmac_f32 v64, v72, v21
    v_fmac_f32 v65, v73, v21
    v_lshlrev_b32 v72, 16, v37
    v_and_b32 v73, 0xffff0000, v37
    v_fmac_f32 v66, v72, v21
    v_fmac_f32 v67, v73, v21
    v_lshlrev_b32 v72, 16, v38
    v_and_b32 v73, 0xffff0000, v38
    v_fmac_f32 v68, v72, v21
    v_fmac_f32 v69, v73, v21
    v_lshlrev_b32 v72, 16, v39
    v_and_b32 v73, 0xffff0000, v39
    v_fmac_f32 v70, v72, v21
    v_fmac_f32 v71, v73, v21
    s_waitcnt vmcnt(4)
    v_lshlrev_b32 v72, 16, v40
    v_and_b32 v73, 0xffff0000, v40
    v_fmac_f32 v64, v72, v22
    v_fmac_f32 v65, v73, v22
    v_lshlrev_b32 v72, 16, v41
    v_and_b32 v73, 0xffff0000, v41
    v_fmac_f32 v66, v72, v22
    v_fmac_f32 v67, v73, v22
    v_lshlrev_b32 v72, 16, v42
    v_and_b32 v73, 0xffff0000, v42
    v_fmac_f32 v68, v72, v22
    v_fmac_f32 v69, v73, v22
    v_lshlrev_b32 v72, 16, v43
    v_and_b32 v73, 0xffff0000, v43
    v_fmac_f32 v70, v72, v22
    v_fmac_f32 v71, v73, v22
    s_waitcnt vmcnt(3)
    v_lshlrev_b32 v72, 16, v44
    v_and_b32 v73, 0xffff0000, v44
    v_fmac_f32 v64, v72, v23
    v_fmac_f32 v65, v73, v23
    v_lshlrev_b32 v72, 16, v45
    v_and_b32 v73, 0xffff0000, v45
    v_fmac_f32 v66, v72, v23
    v_fmac_f32 v67, v73, v23
    v_lshlrev_b32 v72, 16, v46
    v_and_b32 v73, 0xffff0000, v46
    v_fmac_f32 v68, v72, v23
    v_fmac_f32 v69, v73, v23
    v_lshlrev_b32 v72, 16, v47
    v_and_b32 v73, 0xffff0000, v47
    v_fmac_f32 v70, v72, v23
    v_fmac_f32 v71, v73, v23
    s_waitcnt vmcnt(2)
    v_lshlrev_b32 v72, 16, v48
    v_and_b32 v73, 0xffff0000, v48
    v_fmac_f32 v64, v72, v24
    v_fmac_f32 v65, v73, v24
    v_lshlrev_b32 v72, 16, v49
    v_and_b32 v73, 0xffff0000, v49
    v_fmac_f32 v66, v72, v24
    v_fmac_f32 v67, v73, v24
    v_lshlrev_b32 v72, 16, v50
    v_and_b32 v73, 0xffff0000, v50
    v_fmac_f32 v68, v72, v24
    v_fmac_f32 v69, v73, v24
    v_lshlrev_b32 v72, 16, v51
    v_and_b32 v73, 0xffff0000, v51
    v_fmac_f32 v70, v72, v24
    v_fmac_f32 v71, v73, v24
    s_waitcnt vmcnt(1)
    v_lshlrev_b32 v72, 16, v52
    v_and_b32 v73, 0xffff0000, v52
    v_fmac_f32 v64, v72, v25
    v_fmac_f32 v65, v73, v25
    v_lshlrev_b32 v72, 16, v53
    v_and_b32 v73, 0xffff0000, v53
    v_fmac_f32 v66, v72, v25
    v_fmac_f32 v67, v73, v25
    v_lshlrev_b32 v72, 16, v54
    v_and_b32 v73, 0xffff0000, v54
    v_fmac_f32 v68, v72, v25
    v_fmac_f32 v69, v73, v25
    v_lshlrev_b32 v72, 16, v55
    v_and_b32 v73, 0xffff0000, v55
    v_fmac_f32 v70, v72, v25
    v_fmac_f32 v71, v73, v25
    s_waitcnt vmcnt(0)
    v_lshlrev_b32 v72, 16, v56
    v_and_b32 v73, 0xffff0000, v56
    v_fmac_f32 v64, v72, v26
    v_fmac_f32 v65, v73, v26
    v_lshlrev_b32 v72, 16, v57
    v_and_b32 v73, 0xffff0000, v57
    v_fmac_f32 v66, v72, v26
    v_fmac_f32 v67, v73, v26
    v_lshlrev_b32 v72, 16, v58
    v_and_b32 v73, 0xffff0000, v58
    v_fmac_f32 v68, v72, v26
    v_fmac_f32 v69, v73, v26
    v_lshlrev_b32 v72, 16, v59
    v_and_b32 v73, 0xffff0000, v59
    v_fmac_f32 v70, v72, v26
    v_fmac_f32 v71, v73, v26
    s_lshl_b32 s24, s14, 11
    v_lshlrev_b32 v74, 8, v4
    v_lshlrev_b32 v75, 1, v7
    v_add3_u32 v74, v74, v75, s24
    ds_write_b128 v74, v[64:67]
    ds_write_b128 v74, v[68:71] offset:16
    v_lshlrev_b32 v76, 2, v2
    v_add_u32 v77, s24, v76
    s_waitcnt lgkmcnt(0)
    ds_read_b32 v80, v77 offset:0
    ds_read_b32 v81, v77 offset:256
    ds_read_b32 v82, v77 offset:512
    ds_read_b32 v83, v77 offset:768
    ds_read_b32 v84, v77 offset:1024
    ds_read_b32 v85, v77 offset:1280
    ds_read_b32 v86, v77 offset:1536
    ds_read_b32 v87, v77 offset:1792
    s_waitcnt lgkmcnt(0)
    v_add_f32 v80, v80, v81
    v_add_f32 v80, v80, v82
    v_add_f32 v80, v80, v83
    v_add_f32 v80, v80, v84
    v_add_f32 v80, v80, v85
    v_add_f32 v80, v80, v86
    v_add_f32 v80, v80, v87
    buffer_store_dword v80, v76, s[36:39], s22 offen
proj_end:
    s_endpgm
.globl attn_kernel
.p2align 8
.type attn_kernel,@function
attn_kernel:
    s_load_dwordx4 s[4:7], s[0:1], 8
    s_load_dwordx2 s[12:13], s[0:1], 88
    v_lshrrev_b32 v1, 6, v0
    v_and_b32 v2, 63, v0
    s_nop 0
    v_readfirstlane_b32 s14, v1
    s_cmp_ge_u32 s2, 256
    s_cbranch_scc1 attn_end
    s_lshr_b32 s15, s2, 5
    s_and_b32 s16, s2, 31
    s_waitcnt lgkmcnt(0)
    s_lshl_b32 s17, s15, 25
    s_lshl_b32 s18, s16, 16
    s_add_u32 s17, s17, s18
    s_add_u32 s17, s17, 31457280
    s_add_u32 s4, s4, s17
    s_addc_u32 s5, s5, 0
    s_add_u32 s6, s6, s17
    s_addc_u32 s7, s7, 0
    s_mov_b32 s20, s4
    s_mov_b32 s21, s5
    s_mov_b32 s22, 65536
    s_mov_b32 s23, 0x00020000
    s_mov_b32 s24, s6
    s_mov_b32 s25, s7
    s_mov_b32 s26, 65536
    s_mov_b32 s27, 0x00020000
    s_mov_b32 s36, s12
    s_mov_b32 s37, s13
    s_mov_b32 s38, 1073741824
    s_mov_b32 s39, 0x00020000
    v_and_b32 v3, 15, v2
    v_lshrrev_b32 v4, 4, v2
    s_lshl_b32 s18, s14, 13
    v_lshlrev_b32 v5, 9, v3
    v_lshlrev_b32 v6, 4, v4
    v_add3_u32 v5, v5, v6, s18
    buffer_load_dwordx4 v[32:35], v5, s[20:23], 0 offen offset:0 nt
    buffer_load_dwordx4 v[36:39], v5, s[20:23], 0 offen offset:64 nt
    buffer_load_dwordx4 v[40:43], v5, s[20:23], 0 offen offset:128 nt
    buffer_load_dwordx4 v[44:47], v5, s[20:23], 0 offen offset:192 nt
    buffer_load_dwordx4 v[48:51], v5, s[20:23], 0 offen offset:256 nt
    buffer_load_dwordx4 v[52:55], v5, s[20:23], 0 offen offset:320 nt
    buffer_load_dwordx4 v[56:59], v5, s[20:23], 0 offen offset:384 nt
    buffer_load_dwordx4 v[60:63], v5, s[20:23], 0 offen offset:448 nt
    v_lshlrev_b32 v7, 4, v2
    v_add_u32 v7, s18, v7
    s_add_u32 s19, s18, 4096
    s_mov_b32 m0, s19
    s_nop 0
    buffer_load_dwordx4 v7, s[24:27], 0 offen offset:0 nt lds
    buffer_load_dwordx4 v7, s[24:27], 0 offen offset:1024 nt lds
    buffer_load_dwordx4 v7, s[24:27], 0 offen offset:2048 nt lds
    buffer_load_dwordx4 v7, s[24:27], 0 offen offset:3072 nt lds
    s_add_u32 s19, s18, 8192
    s_mov_b32 m0, s19
    v_add_u32 v7, 4096, v7
    buffer_load_dwordx4 v7, s[24:27], 0 offen offset:0 nt lds
    buffer_load_dwordx4 v7, s[24:27], 0 offen offset:1024 nt lds
    buffer_load_dwordx4 v7, s[24:27], 0 offen offset:2048 nt lds
    buffer_load_dwordx4 v7, s[24:27], 0 offen offset:3072 nt lds
    s_lshl_b32 s19, s15, 11
    v_lshlrev_b32 v8, 2, v0
    v_add_u32 v8, s19, v8
    s_mov_b32 s40, 0
    buffer_load_dword v10, v8, s[36:39], s40 offen
    s_mov_b32 s40, 16384
    buffer_load_dword v11, v8, s[36:39], s40 offen
    s_mov_b32 s40, 32768
    buffer_load_dword v12, v8, s[36:39], s40 offen
    s_mov_b32 s40, 49152
    buffer_load_dword v13, v8, s[36:39], s40 offen
    s_mov_b32 s40, 65536
    buffer_load_dword v14, v8, s[36:39], s40 offen
    s_mov_b32 s40, 81920
    buffer_load_dword v15, v8, s[36:39], s40 offen
    s_mov_b32 s40, 98304
    buffer_load_dword v16, v8, s[36:39], s40 offen
    s_mov_b32 s40, 114688
    buffer_load_dword v17, v8, s[36:39], s40 offen
    s_waitcnt vmcnt(0)
    v_add_f32 v10, v10, v11
    v_add_f32 v10, v10, v12
    v_add_f32 v10, v10, v13
    v_add_f32 v10, v10, v14
    v_add_f32 v10, v10, v15
    v_add_f32 v10, v10, v16
    v_add_f32 v10, v10, v17
    v_cvt_pk_bf16_f32 v10, v10, v10
    v_lshlrev_b32 v9, 1, v0
    ds_write_b16 v9, v10 offset:0
    s_waitcnt lgkmcnt(0)
    s_barrier
    v_and_b32 v9, 1, v2
    v_lshlrev_b32 v9, 9, v9
    v_add_u32 v9, v9, v6
    ds_read_b128 v[64:67], v9 offset:0
    ds_read_b128 v[68:71], v9 offset:64
    ds_read_b128 v[72:75], v9 offset:128
    ds_read_b128 v[76:79], v9 offset:192
    ds_read_b128 v[80:83], v9 offset:256
    ds_read_b128 v[84:87], v9 offset:320
    ds_read_b128 v[88:91], v9 offset:384
    ds_read_b128 v[92:95], v9 offset:448
    v_mov_b32 v96, 0
    v_mov_b32 v97, 0
    v_mov_b32 v98, 0
    v_mov_b32 v99, 0
    s_waitcnt lgkmcnt(0)
    s_nop 1
    v_mfma_f32_16x16x32_bf16 v[96:99], v[64:67], v[32:35], v[96:99]
    v_mfma_f32_16x16x32_bf16 v[96:99], v[68:71], v[36:39], v[96:99]
    v_mfma_f32_16x16x32_bf16 v[96:99], v[72:75], v[40:43], v[96:99]
    v_mfma_f32_16x16x32_bf16 v[96:99], v[76:79], v[44:47], v[96:99]
    v_mfma_f32_16x16x32_bf16 v[96:99], v[80:83], v[48:51], v[96:99]
    v_mfma_f32_16x16x32_bf16 v[96:99], v[84:87], v[52:55], v[96:99]
    v_mfma_f32_16x16x32_bf16 v[96:99], v[88:91], v[56:59], v[96:99]
    v_mfma_f32_16x16x32_bf16 v[96:99], v[92:95], v[60:63], v[96:99]
    s_nop 7
    s_nop 1
    v_cvt_pk_bf16_f32 v96, v96, v96
    v_lshlrev_b32 v96, 16, v96
    v_cvt_pk_bf16_f32 v97, v97, v97
    v_lshlrev_b32 v97, 16, v97
    v_mul_f32 v96, 0x3d800000, v96
    v_mul_f32 v97, 0x3d800000, v97
    s_lshl_b32 s19, s14, 6
    v_lshlrev_b32 v9, 2, v2
    v_add_u32 v9, s19, v9
    s_mov_b64 exec, 0xffff
    ds_write_b32 v9, v96 offset:1024
    ds_write_b32 v9, v97 offset:1536
    s_mov_b64 exec, -1
    s_waitcnt vmcnt(0) lgkmcnt(0)
    s_barrier
    v_lshlrev_b32 v9, 3, v2
    ds_read_b64 v[10:11], v9 offset:1024
    ds_read_b64 v[12:13], v9 offset:1536
    s_waitcnt lgkmcnt(0)
    v_max_f32 v14, v10, v11
    v_max_f32 v15, v12, v13
    s_nop 1
    v_max_f32_dpp v14, v14, v14 quad_perm:[1,0,3,2] row_mask:0xf bank_mask:0xf
    s_nop 1
    v_max_f32_dpp v14, v14, v14 quad_perm:[2,3,0,1] row_mask:0xf bank_mask:0xf
    s_nop 1
    v_max_f32_dpp v14, v14, v14 row_half_mirror row_mask:0xf bank_mask:0xf
    s_nop 1
    v_max_f32_dpp v14, v14, v14 row_mirror row_mask:0xf bank_mask:0xf
    s_nop 1
    v_readlane_b32 s40, v14, 0
    v_readlane_b32 s41, v14, 16
    v_readlane_b32 s42, v14, 32
    v_readlane_b32 s43, v14, 48
    s_nop 1
    v_mov_b32 v14, s40
    v_max_f32 v14, s41, v14
    v_max_f32 v14, s42, v14
    v_max_f32 v14, s43, v14
    s_nop 1
    v_max_f32_dpp v15, v15, v15 quad_perm:[1,0,3,2] row_mask:0xf bank_mask:0xf
    s_nop 1
    v_max_f32_dpp v15, v15, v15 quad_perm:[2,3,0,1] row_mask:0xf bank_mask:0xf
    s_nop 1
    v_max_f32_dpp v15, v15, v15 row_half_mirror row_mask:0xf bank_mask:0xf
    s_nop 1
    v_max_f32_dpp v15, v15, v15 row_mirror row_mask:0xf bank_mask:0xf
    s_nop 1
    v_readlane_b32 s40, v15, 0
    v_readlane_b32 s41, v15, 16
    v_readlane_b32 s42, v15, 32
    v_readlane_b32 s43, v15, 48
    s_nop 1
    v_mov_b32 v15, s40
    v_max_f32 v15, s41, v15
    v_max_f32 v15, s42, v15
    v_max_f32 v15, s43, v15
    v_sub_f32 v10, v10, v14
    v_mul_f32 v10, 0x3fb8aa3b, v10
    v_exp_f32 v10, v10
    v_sub_f32 v11, v11, v14
    v_mul_f32 v11, 0x3fb8aa3b, v11
    v_exp_f32 v11, v11
    v_sub_f32 v12, v12, v15
    v_mul_f32 v12, 0x3fb8aa3b, v12
    v_exp_f32 v12, v12
    v_sub_f32 v13, v13, v15
    v_mul_f32 v13, 0x3fb8aa3b, v13
    v_exp_f32 v13, v13
    s_nop 0
    v_add_f32 v16, v10, v11
    v_add_f32 v17, v12, v13
    s_nop 1
    v_add_f32_dpp v16, v16, v16 quad_perm:[1,0,3,2] row_mask:0xf bank_mask:0xf
    s_nop 1
    v_add_f32_dpp v16, v16, v16 quad_perm:[2,3,0,1] row_mask:0xf bank_mask:0xf
    s_nop 1
    v_add_f32_dpp v16, v16, v16 row_half_mirror row_mask:0xf bank_mask:0xf
    s_nop 1
    v_add_f32_dpp v16, v16, v16 row_mirror row_mask:0xf bank_mask:0xf
    s_nop 1
    v_readlane_b32 s40, v16, 0
    v_readlane_b32 s41, v16, 16
    v_readlane_b32 s42, v16, 32
    v_readlane_b32 s43, v16, 48
    s_nop 1
    v_mov_b32 v16, s40
    v_add_f32 v16, s41, v16
    v_add_f32 v16, s42, v16
    v_add_f32 v16, s43, v16
    s_nop 1
    v_add_f32_dpp v17, v17, v17 quad_perm:[1,0,3,2] row_mask:0xf bank_mask:0xf
    s_nop 1
    v_add_f32_dpp v17, v17, v17 quad_perm:[2,3,0,1] row_mask:0xf bank_mask:0xf
    s_nop 1
    v_add_f32_dpp v17, v17, v17 row_half_mirror row_mask:0xf bank_mask:0xf
    s_nop 1
    v_add_f32_dpp v17, v17, v17 row_mirror row_mask:0xf bank_mask:0xf
    s_nop 1
    v_readlane_b32 s40, v17, 0
    v_readlane_b32 s41, v17, 16
    v_readlane_b32 s42, v17, 32
    v_readlane_b32 s43, v17, 48
    s_nop 1
    v_mov_b32 v17, s40
    v_add_f32 v17, s41, v17
    v_add_f32 v17, s42, v17
    v_add_f32 v17, s43, v17
    v_cvt_pk_bf16_f32 v18, v10, v11
    v_cvt_pk_bf16_f32 v19, v12, v13
    v_lshlrev_b32 v9, 2, v2
    ds_write_b32 v9, v18 offset:2048
    ds_write_b32 v9, v19 offset:2304
    s_waitcnt lgkmcnt(0)
    v_and_b32 v9, 1, v2
    v_lshlrev_b32 v9, 8, v9
    v_add_u32 v9, v9, v6
    ds_read_b128 v[64:67], v9 offset:2048
    ds_read_b128 v[68:71], v9 offset:2112
    ds_read_b128 v[72:75], v9 offset:2176
    ds_read_b128 v[76:79], v9 offset:2240
    v_lshlrev_b32 v20, 12, v4
    v_lshrrev_b32 v21, 2, v3
    v_lshlrev_b32 v21, 9, v21
    v_and_b32 v22, 3, v3
    v_lshlrev_b32 v22, 3, v22
    v_add3_u32 v20, v20, v21, v22
    s_lshl_b32 s19, s14, 6
    v_add_u32 v20, s19, v20
    v_mov_b32 v100, 0
    v_mov_b32 v101, 0
    v_mov_b32 v102, 0
    v_mov_b32 v103, 0
    ds_read_b64_tr_b16 v[80:81], v20 offset:4096
    ds_read_b64_tr_b16 v[82:83], v20 offset:6144
    ds_read_b64_tr_b16 v[84:85], v20 offset:20480
    ds_read_b64_tr_b16 v[86:87], v20 offset:22528
    ds_read_b64_tr_b16 v[88:89], v20 offset:36864
    ds_read_b64_tr_b16 v[90:91], v20 offset:38912
    ds_read_b64_tr_b16 v[92:93], v20 offset:53248
    ds_read_b64_tr_b16 v[94:95], v20 offset:55296
    s_waitcnt lgkmcnt(0)
    v_mfma_f32_16x16x32_bf16 v[100:103], v[64:67], v[80:83], v[100:103]
    v_mfma_f32_16x16x32_bf16 v[100:103], v[68:71], v[84:87], v[100:103]
    v_mfma_f32_16x16x32_bf16 v[100:103], v[72:75], v[88:91], v[100:103]
    v_mfma_f32_16x16x32_bf16 v[100:103], v[76:79], v[92:95], v[100:103]
    s_nop 7
    s_nop 1
    s_lshl_b32 s40, s2, 11
    s_add_u32 s40, s40, 262144
    s_lshl_b32 s41, s14, 7
    s_add_u32 s40, s40, s41
    v_lshlrev_b32 v9, 2, v2
    s_mov_b64 exec, 0xffff
    buffer_store_dword v100, v9, s[36:39], s40 offen
    buffer_store_dword v101, v9, s[36:39], s40 offen offset:1024
    s_mov_b64 exec, -1
    v_mov_b32 v100, 0
    v_mov_b32 v101, 0
    v_mov_b32 v102, 0
    v_mov_b32 v103, 0
    ds_read_b64_tr_b16 v[80:81], v20 offset:4128
    ds_read_b64_tr_b16 v[82:83], v20 offset:6176
    ds_read_b64_tr_b16 v[84:85], v20 offset:20512
    ds_read_b64_tr_b16 v[86:87], v20 offset:22560
    ds_read_b64_tr_b16 v[88:89], v20 offset:36896
    ds_read_b64_tr_b16 v[90:91], v20 offset:38944
    ds_read_b64_tr_b16 v[92:93], v20 offset:53280
    ds_read_b64_tr_b16 v[94:95], v20 offset:55328
    s_waitcnt lgkmcnt(0)
    v_mfma_f32_16x16x32_bf16 v[100:103], v[64:67], v[80:83], v[100:103]
    v_mfma_f32_16x16x32_bf16 v[100:103], v[68:71], v[84:87], v[100:103]
    v_mfma_f32_16x16x32_bf16 v[100:103], v[72:75], v[88:91], v[100:103]
    v_mfma_f32_16x16x32_bf16 v[100:103], v[76:79], v[92:95], v[100:103]
    s_nop 7
    s_nop 1
    s_lshl_b32 s40, s2, 11
    s_add_u32 s40, s40, 262208
    s_lshl_b32 s41, s14, 7
    s_add_u32 s40, s40, s41
    v_lshlrev_b32 v9, 2, v2
    s_mov_b64 exec, 0xffff
    buffer_store_dword v100, v9, s[36:39], s40 offen
    buffer_store_dword v101, v9, s[36:39], s40 offen offset:1024
    s_mov_b64 exec, -1
    s_cmp_lg_u32 s14, 0
    s_cbranch_scc1 attn_end
    v_mov_b32 v24, v14
    v_mov_b32 v25, v15
    v_mov_b32 v26, v16
    v_mov_b32 v27, v17
    v_mov_b32 v9, 0
    s_lshl_b32 s40, s2, 4
    s_add_u32 s40, s40, 786432
    s_mov_b64 exec, 1
    buffer_store_dwordx4 v[24:27], v9, s[36:39], s40 offen
attn_end:
    s_endpgm
.globl outp_kernel
.p2align 8
.type outp_kernel,@function
outp_kernel:
    s_load_dwordx2 s[4:5], s[0:1], 32
    s_load_dwordx2 s[6:7], s[0:1], 64
    s_load_dwordx2 s[12:13], s[0:1], 88
    v_lshrrev_b32 v1, 6, v0
    v_and_b32 v2, 63, v0
    s_nop 0
    v_readfirstlane_b32 s14, v1
    s_cmp_ge_u32 s2, 256
    s_cbranch_scc1 outp_end
    s_lshr_b32 s15, s2, 4
    s_and_b32 s16, s2, 15
    s_lshr_b32 s17, s15, 1
    s_and_b32 s18, s15, 1
    s_waitcnt lgkmcnt(0)
    s_mov_b32 s20, s4
    s_mov_b32 s21, s5
    s_mov_b32 s22, 3670016
    s_mov_b32 s23, 0x00020000
    s_mov_b32 s24, s6
    s_mov_b32 s25, s7
    s_mov_b32 s26, 1605632
    s_mov_b32 s27, 0x00020000
    s_mov_b32 s36, s12
    s_mov_b32 s37, s13
    s_mov_b32 s38, 1073741824
    s_mov_b32 s39, 0x00020000
    s_lshl_b32 s19, s15, 8
    s_lshl_b32 s40, s16, 4
    s_add_u32 s19, s19, s40
    s_lshl_b32 s40, s14, 1
    s_add_u32 s19, s19, s40
    s_mul_i32 s19, s19, 896
    v_lshlrev_b32 v3, 4, v2
    v_cmp_gt_u32 vcc, 56, v2
    s_and_saveexec_b64 s[42:43], vcc
    buffer_load_dwordx4 v[32:35], v3, s[20:23], s19 offen nt
    buffer_load_dwordx4 v[36:39], v3, s[20:23], s19 offen offset:896 nt
    s_mul_i32 s44, s2, 7
    s_add_u32 s44, s44, s14
    s_mul_i32 s45, s44, 896
    buffer_load_dwordx4 v[40:43], v3, s[24:27], s45 offen nt
    s_mov_b64 exec, s[42:43]
    s_lshl_b32 s46, s44, 2
    v_mov_b32 v4, 0
    s_add_u32 s47, s46, 131072
    buffer_load_dword v48, v4, s[36:39], s47 offen
    s_add_u32 s48, s47, 7168
    buffer_load_dword v56, v4, s[36:39], s48 offen
    s_add_u32 s47, s46, 145408
    buffer_load_dword v49, v4, s[36:39], s47 offen
    s_add_u32 s48, s47, 7168
    buffer_load_dword v57, v4, s[36:39], s48 offen
    s_add_u32 s47, s46, 159744
    buffer_load_dword v50, v4, s[36:39], s47 offen
    s_add_u32 s48, s47, 7168
    buffer_load_dword v58, v4, s[36:39], s48 offen
    s_add_u32 s47, s46, 174080
    buffer_load_dword v51, v4, s[36:39], s47 offen
    s_add_u32 s48, s47, 7168
    buffer_load_dword v59, v4, s[36:39], s48 offen
    s_add_u32 s47, s46, 188416
    buffer_load_dword v52, v4, s[36:39], s47 offen
    s_add_u32 s48, s47, 7168
    buffer_load_dword v60, v4, s[36:39], s48 offen
    s_add_u32 s47, s46, 202752
    buffer_load_dword v53, v4, s[36:39], s47 offen
    s_add_u32 s48, s47, 7168
    buffer_load_dword v61, v4, s[36:39], s48 offen
    s_add_u32 s47, s46, 217088
    buffer_load_dword v54, v4, s[36:39], s47 offen
    s_add_u32 s48, s47, 7168
    buffer_load_dword v62, v4, s[36:39], s48 offen
    s_add_u32 s47, s46, 231424
    buffer_load_dword v55, v4, s[36:39], s47 offen
    s_add_u32 s48, s47, 7168
    buffer_load_dword v63, v4, s[36:39], s48 offen
    s_lshl_b32 s47, s17, 9
    s_add_u32 s47, s47, 786432
    v_and_b32 v5, 31, v2
    v_lshlrev_b32 v5, 4, v5
    buffer_load_dwordx4 v[64:67], v5, s[36:39], s47 offen
    v_lshrrev_b32 v6, 4, v0
    v_and_b32 v7, 15, v0
    v_lshlrev_b32 v8, 11, v6
    v_lshlrev_b32 v9, 2, v7
    v_add_u32 v8, v8, v9
    s_lshl_b32 s47, s17, 16
    s_lshl_b32 s48, s18, 10
    s_add_u32 s47, s47, s48
    s_lshl_b32 s48, s16, 6
    s_add_u32 s47, s47, s48
    s_add_u32 s47, s47, 262144
    buffer_load_dword v68, v8, s[36:39], s47 offen
    v_lshlrev_b32 v9, 4, v6
    s_lshl_b32 s47, s17, 9
    s_add_u32 s47, s47, 786432
    buffer_load_dwordx4 v[72:75], v9, s[36:39], s47 offen
    s_waitcnt vmcnt(0)
    s_cmp_eq_u32 s18, 1
    s_cselect_b64 vcc, -1, 0
    v_cndmask_b32 v64, v64, v65, vcc
    v_cndmask_b32 v66, v66, v67, vcc
    v_cndmask_b32 v72, v72, v73, vcc
    v_mov_b32 v76, v64
    s_nop 1
    v_max_f32_dpp v76, v76, v76 quad_perm:[1,0,3,2] row_mask:0xf bank_mask:0xf
    s_nop 1
    v_max_f32_dpp v76, v76, v76 quad_perm:[2,3,0,1] row_mask:0xf bank_mask:0xf
    s_nop 1
    v_max_f32_dpp v76, v76, v76 row_half_mirror row_mask:0xf bank_mask:0xf
    s_nop 1
    v_max_f32_dpp v76, v76, v76 row_mirror row_mask:0xf bank_mask:0xf
    s_nop 1
    v_readlane_b32 s40, v76, 0
    v_readlane_b32 s41, v76, 16
    v_readlane_b32 s42, v76, 32
    v_readlane_b32 s43, v76, 48
    s_nop 1
    v_mov_b32 v76, s40
    v_max_f32 v76, s41, v76
    v_max_f32 v76, s42, v76
    v_max_f32 v76, s43, v76
    v_sub_f32 v64, v64, v76
    v_mul_f32 v64, 0x3fb8aa3b, v64
    v_exp_f32 v64, v64
    s_nop 0
    v_mul_f32 v64, v64, v66
    v_cmp_gt_u32 vcc, 32, v2
    s_nop 1
    v_cndmask_b32 v64, 0, v64, vcc
    s_nop 1
    v_add_f32_dpp v64, v64, v64 quad_perm:[1,0,3,2] row_mask:0xf bank_mask:0xf
    s_nop 1
    v_add_f32_dpp v64, v64, v64 quad_perm:[2,3,0,1] row_mask:0xf bank_mask:0xf
    s_nop 1
    v_add_f32_dpp v64, v64, v64 row_half_mirror row_mask:0xf bank_mask:0xf
    s_nop 1
    v_add_f32_dpp v64, v64, v64 row_mirror row_mask:0xf bank_mask:0xf
    s_nop 1
    v_readlane_b32 s40, v64, 0
    v_readlane_b32 s41, v64, 16
    v_readlane_b32 s42, v64, 32
    v_readlane_b32 s43, v64, 48
    s_nop 1
    v_mov_b32 v64, s40
    v_add_f32 v64, s41, v64
    v_add_f32 v64, s42, v64
    v_add_f32 v64, s43, v64
    v_rcp_f32 v64, v64
    v_sub_f32 v72, v72, v76
    v_mul_f32 v72, 0x3fb8aa3b, v72
    v_exp_f32 v72, v72
    s_nop 0
    v_mul_f32 v68, v68, v72
    v_mul_f32 v68, v68, v64
    v_lshlrev_b32 v9, 2, v0
    ds_write_b32 v9, v68 offset:0
    s_waitcnt lgkmcnt(0)
    s_barrier
    v_and_b32 v9, 31, v2
    v_lshlrev_b32 v9, 6, v9
    s_lshl_b32 s47, s14, 3
    v_add_u32 v9, s47, v9
    ds_read_b64 v[70:71], v9 offset:0
    s_waitcnt lgkmcnt(0)
    v_cmp_gt_u32 vcc, 32, v2
    s_nop 1
    v_cndmask_b32 v70, 0, v70, vcc
    v_cndmask_b32 v71, 0, v71, vcc
    s_nop 1
    v_add_f32_dpp v70, v70, v70 quad_perm:[1,0,3,2] row_mask:0xf bank_mask:0xf
    s_nop 1
    v_add_f32_dpp v70, v70, v70 quad_perm:[2,3,0,1] row_mask:0xf bank_mask:0xf
    s_nop 1
    v_add_f32_dpp v70, v70, v70 row_half_mirror row_mask:0xf bank_mask:0xf
    s_nop 1
    v_add_f32_dpp v70, v70, v70 row_mirror row_mask:0xf bank_mask:0xf
    s_nop 1
    v_readlane_b32 s40, v70, 0
    v_readlane_b32 s41, v70, 16
    v_readlane_b32 s42, v70, 32
    v_readlane_b32 s43, v70, 48
    s_nop 1
    v_mov_b32 v70, s40
    v_add_f32 v70, s41, v70
    v_add_f32 v70, s42, v70
    v_add_f32 v70, s43, v70
    s_nop 1
    v_add_f32_dpp v71, v71, v71 quad_perm:[1,0,3,2] row_mask:0xf bank_mask:0xf
    s_nop 1
    v_add_f32_dpp v71, v71, v71 quad_perm:[2,3,0,1] row_mask:0xf bank_mask:0xf
    s_nop 1
    v_add_f32_dpp v71, v71, v71 row_half_mirror row_mask:0xf bank_mask:0xf
    s_nop 1
    v_add_f32_dpp v71, v71, v71 row_mirror row_mask:0xf bank_mask:0xf
    s_nop 1
    v_readlane_b32 s40, v71, 0
    v_readlane_b32 s41, v71, 16
    v_readlane_b32 s42, v71, 32
    v_readlane_b32 s43, v71, 48
    s_nop 1
    v_mov_b32 v71, s40
    v_add_f32 v71, s41, v71
    v_add_f32 v71, s42, v71
    v_add_f32 v71, s43, v71
    v_cvt_pk_bf16_f32 v70, v70, v70
    v_lshlrev_b32 v70, 16, v70
    v_cvt_pk_bf16_f32 v71, v71, v71
    v_lshlrev_b32 v71, 16, v71
    v_lshlrev_b32 v80, 16, v32
    v_and_b32 v81, 0xffff0000, v32
    v_mul_f32 v84, v80, v70
    v_mul_f32 v85, v81, v70
    v_lshlrev_b32 v80, 16, v36
    v_and_b32 v81, 0xffff0000, v36
    v_fmac_f32 v84, v80, v71
    v_fmac_f32 v85, v81, v71
    v_lshlrev_b32 v80, 16, v33
    v_and_b32 v81, 0xffff0000, v33
    v_mul_f32 v86, v80, v70
    v_mul_f32 v87, v81, v70
    v_lshlrev_b32 v80, 16, v37
    v_and_b32 v81, 0xffff0000, v37
    v_fmac_f32 v86, v80, v71
    v_fmac_f32 v87, v81, v71
    v_lshlrev_b32 v80, 16, v34
    v_and_b32 v81, 0xffff0000, v34
    v_mul_f32 v88, v80, v70
    v_mul_f32 v89, v81, v70
    v_lshlrev_b32 v80, 16, v38
    v_and_b32 v81, 0xffff0000, v38
    v_fmac_f32 v88, v80, v71
    v_fmac_f32 v89, v81, v71
    v_lshlrev_b32 v80, 16, v35
    v_and_b32 v81, 0xffff0000, v35
    v_mul_f32 v90, v80, v70
    v_mul_f32 v91, v81, v70
    v_lshlrev_b32 v80, 16, v39
    v_and_b32 v81, 0xffff0000, v39
    v_fmac_f32 v90, v80, v71
    v_fmac_f32 v91, v81, v71
    v_add_f32 v48, v48, v49
    v_add_f32 v56, v56, v57
    v_add_f32 v48, v48, v50
    v_add_f32 v56, v56, v58
    v_add_f32 v48, v48, v51
    v_add_f32 v56, v56, v59
    v_add_f32 v48, v48, v52
    v_add_f32 v56, v56, v60
    v_add_f32 v48, v48, v53
    v_add_f32 v56, v56, v61
    v_add_f32 v48, v48, v54
    v_add_f32 v56, v56, v62
    v_add_f32 v48, v48, v55
    v_add_f32 v56, v56, v63
    v_cvt_pk_bf16_f32 v48, v48, v48
    v_lshlrev_b32 v48, 16, v48
    v_cvt_pk_bf16_f32 v56, v56, v56
    v_lshlrev_b32 v56, 16, v56
    v_mul_f32 v49, 0xbfb8aa3b, v48
    v_exp_f32 v49, v49
    s_nop 0
    v_add_f32 v49, 1.0, v49
    v_rcp_f32 v49, v49
    s_nop 0
    v_cvt_pk_bf16_f32 v49, v49, v49
    v_lshlrev_b32 v49, 16, v49
    v_mul_f32 v49, v49, v56
    v_cvt_pk_bf16_f32 v49, v49, v49
    v_lshlrev_b32 v49, 16, v49
    v_lshlrev_b32 v80, 16, v40
    v_and_b32 v81, 0xffff0000, v40
    v_mul_f32 v92, v80, v49
    v_mul_f32 v93, v81, v49
    v_lshlrev_b32 v80, 16, v41
    v_and_b32 v81, 0xffff0000, v41
    v_mul_f32 v94, v80, v49
    v_mul_f32 v95, v81, v49
    v_lshlrev_b32 v80, 16, v42
    v_and_b32 v81, 0xffff0000, v42
    v_mul_f32 v96, v80, v49
    v_mul_f32 v97, v81, v49
    v_lshlrev_b32 v80, 16, v43
    v_and_b32 v81, 0xffff0000, v43
    v_mul_f32 v98, v80, v49
    v_mul_f32 v99, v81, v49
    s_mul_i32 s47, s14, 1792
    v_lshlrev_b32 v9, 5, v2
    v_add_u32 v9, s47, v9
    v_cmp_gt_u32 vcc, 56, v2
    s_and_saveexec_b64 s[42:43], vcc
    ds_write_b128 v9, v[84:87] offset:2048
    ds_write_b128 v9, v[88:91] offset:2064
    s_cmp_ge_u32 s14, 7
    s_cbranch_scc1 outp_skipb
    ds_write_b128 v9, v[92:95] offset:16384
    ds_write_b128 v9, v[96:99] offset:16400
outp_skipb:
    s_mov_b64 exec, s[42:43]
    s_waitcnt lgkmcnt(0)
    s_barrier
    v_cmp_gt_u32 vcc, 448, v0
    s_and_saveexec_b64 s[42:43], vcc
    s_cbranch_execz outp_end
    v_lshlrev_b32 v9, 2, v0
    ds_read_b32 v100, v9 offset:2048
    ds_read_b32 v101, v9 offset:3840
    ds_read_b32 v102, v9 offset:5632
    ds_read_b32 v103, v9 offset:7424
    ds_read_b32 v104, v9 offset:9216
    ds_read_b32 v105, v9 offset:11008
    ds_read_b32 v106, v9 offset:12800
    ds_read_b32 v107, v9 offset:14592
    ds_read_b32 v108, v9 offset:16384
    ds_read_b32 v109, v9 offset:18176
    ds_read_b32 v110, v9 offset:19968
    ds_read_b32 v111, v9 offset:21760
    ds_read_b32 v112, v9 offset:23552
    ds_read_b32 v113, v9 offset:25344
    ds_read_b32 v114, v9 offset:27136
    s_waitcnt lgkmcnt(0)
    v_add_f32 v100, v100, v101
    v_add_f32 v100, v100, v102
    v_add_f32 v100, v100, v103
    v_add_f32 v100, v100, v104
    v_add_f32 v100, v100, v105
    v_add_f32 v100, v100, v106
    v_add_f32 v100, v100, v107
    v_add_f32 v108, v108, v109
    v_add_f32 v108, v108, v110
    v_add_f32 v108, v108, v111
    v_add_f32 v108, v108, v112
    v_add_f32 v108, v108, v113
    v_add_f32 v108, v108, v114
    s_mul_i32 s47, s2, 3584
    s_add_u32 s47, s47, 1048576
    buffer_store_dword v100, v9, s[36:39], s47 offen
    buffer_store_dword v108, v9, s[36:39], s47 offen offset:1792
outp_end:
    s_endpgm
.globl final_kernel
.p2align 8
.type final_kernel,@function
final_kernel:
    s_load_dwordx2 s[4:5], s[0:1], 0
    s_load_dwordx2 s[6:7], s[0:1], 72
    s_load_dwordx2 s[12:13], s[0:1], 88
    v_lshrrev_b32 v1, 6, v0
    v_and_b32 v2, 63, v0
    s_nop 0
    v_readfirstlane_b32 s14, v1
    s_cmp_ge_u32 s2, 7
    s_cbranch_scc1 final_end
    s_waitcnt lgkmcnt(0)
    s_mov_b32 s20, s4
    s_mov_b32 s21, s5
    s_mov_b32 s22, 896
    s_mov_b32 s23, 0x00020000
    s_mov_b32 s24, s6
    s_mov_b32 s25, s7
    s_mov_b32 s26, 896
    s_mov_b32 s27, 0x00020000
    s_mov_b32 s36, s12
    s_mov_b32 s37, s13
    s_mov_b32 s38, 1073741824
    s_mov_b32 s39, 0x00020000
    s_lshl_b32 s15, s2, 6
    v_add_u32 v3, s15, v2
    v_lshlrev_b32 v4, 2, v3
    s_mul_i32 s16, s14, 57344
    s_add_u32 s16, s16, 1048576
    buffer_load_dword v10, v4, s[36:39], s16 offen
    buffer_load_dword v11, v4, s[36:39], s16 offen offset:1792
    s_add_u32 s16, s16, 3584
    buffer_load_dword v12, v4, s[36:39], s16 offen
    buffer_load_dword v13, v4, s[36:39], s16 offen offset:1792
    s_add_u32 s16, s16, 3584
    buffer_load_dword v14, v4, s[36:39], s16 offen
    buffer_load_dword v15, v4, s[36:39], s16 offen offset:1792
    s_add_u32 s16, s16, 3584
    buffer_load_dword v16, v4, s[36:39], s16 offen
    buffer_load_dword v17, v4, s[36:39], s16 offen offset:1792
    s_add_u32 s16, s16, 3584
    buffer_load_dword v18, v4, s[36:39], s16 offen
    buffer_load_dword v19, v4, s[36:39], s16 offen offset:1792
    s_add_u32 s16, s16, 3584
    buffer_load_dword v20, v4, s[36:39], s16 offen
    buffer_load_dword v21, v4, s[36:39], s16 offen offset:1792
    s_add_u32 s16, s16, 3584
    buffer_load_dword v22, v4, s[36:39], s16 offen
    buffer_load_dword v23, v4, s[36:39], s16 offen offset:1792
    s_add_u32 s16, s16, 3584
    buffer_load_dword v24, v4, s[36:39], s16 offen
    buffer_load_dword v25, v4, s[36:39], s16 offen offset:1792
    s_add_u32 s16, s16, 3584
    buffer_load_dword v26, v4, s[36:39], s16 offen
    buffer_load_dword v27, v4, s[36:39], s16 offen offset:1792
    s_add_u32 s16, s16, 3584
    buffer_load_dword v28, v4, s[36:39], s16 offen
    buffer_load_dword v29, v4, s[36:39], s16 offen offset:1792
    s_add_u32 s16, s16, 3584
    buffer_load_dword v30, v4, s[36:39], s16 offen
    buffer_load_dword v31, v4, s[36:39], s16 offen offset:1792
    s_add_u32 s16, s16, 3584
    buffer_load_dword v32, v4, s[36:39], s16 offen
    buffer_load_dword v33, v4, s[36:39], s16 offen offset:1792
    s_add_u32 s16, s16, 3584
    buffer_load_dword v34, v4, s[36:39], s16 offen
    buffer_load_dword v35, v4, s[36:39], s16 offen offset:1792
    s_add_u32 s16, s16, 3584
    buffer_load_dword v36, v4, s[36:39], s16 offen
    buffer_load_dword v37, v4, s[36:39], s16 offen offset:1792
    s_add_u32 s16, s16, 3584
    buffer_load_dword v38, v4, s[36:39], s16 offen
    buffer_load_dword v39, v4, s[36:39], s16 offen offset:1792
    s_add_u32 s16, s16, 3584
    buffer_load_dword v40, v4, s[36:39], s16 offen
    buffer_load_dword v41, v4, s[36:39], s16 offen offset:1792
    s_add_u32 s16, s16, 3584
    s_waitcnt vmcnt(0)
    v_add_f32 v10, v10, v12
    v_add_f32 v11, v11, v13
    v_add_f32 v10, v10, v14
    v_add_f32 v11, v11, v15
    v_add_f32 v10, v10, v16
    v_add_f32 v11, v11, v17
    v_add_f32 v10, v10, v18
    v_add_f32 v11, v11, v19
    v_add_f32 v10, v10, v20
    v_add_f32 v11, v11, v21
    v_add_f32 v10, v10, v22
    v_add_f32 v11, v11, v23
    v_add_f32 v10, v10, v24
    v_add_f32 v11, v11, v25
    v_add_f32 v10, v10, v26
    v_add_f32 v11, v11, v27
    v_add_f32 v10, v10, v28
    v_add_f32 v11, v11, v29
    v_add_f32 v10, v10, v30
    v_add_f32 v11, v11, v31
    v_add_f32 v10, v10, v32
    v_add_f32 v11, v11, v33
    v_add_f32 v10, v10, v34
    v_add_f32 v11, v11, v35
    v_add_f32 v10, v10, v36
    v_add_f32 v11, v11, v37
    v_add_f32 v10, v10, v38
    v_add_f32 v11, v11, v39
    v_add_f32 v10, v10, v40
    v_add_f32 v11, v11, v41
    v_lshlrev_b32 v5, 3, v0
    ds_write_b64 v5, v[10:11]
    s_waitcnt lgkmcnt(0)
    s_barrier
    s_cmp_lg_u32 s14, 0
    s_cbranch_scc1 final_end
    v_lshlrev_b32 v5, 3, v2
    ds_read_b64 v[10:11], v5 offset:0
    ds_read_b64 v[12:13], v5 offset:512
    ds_read_b64 v[14:15], v5 offset:1024
    ds_read_b64 v[16:17], v5 offset:1536
    ds_read_b64 v[18:19], v5 offset:2048
    ds_read_b64 v[20:21], v5 offset:2560
    ds_read_b64 v[22:23], v5 offset:3072
    ds_read_b64 v[24:25], v5 offset:3584
    ds_read_b64 v[26:27], v5 offset:4096
    ds_read_b64 v[28:29], v5 offset:4608
    ds_read_b64 v[30:31], v5 offset:5120
    ds_read_b64 v[32:33], v5 offset:5632
    ds_read_b64 v[34:35], v5 offset:6144
    ds_read_b64 v[36:37], v5 offset:6656
    ds_read_b64 v[38:39], v5 offset:7168
    ds_read_b64 v[40:41], v5 offset:7680
    v_lshlrev_b32 v6, 1, v3
    buffer_load_ushort v50, v6, s[20:23], 0 offen
    s_waitcnt lgkmcnt(0)
    v_add_f32 v10, v10, v12
    v_add_f32 v11, v11, v13
    v_add_f32 v10, v10, v14
    v_add_f32 v11, v11, v15
    v_add_f32 v10, v10, v16
    v_add_f32 v11, v11, v17
    v_add_f32 v10, v10, v18
    v_add_f32 v11, v11, v19
    v_add_f32 v10, v10, v20
    v_add_f32 v11, v11, v21
    v_add_f32 v10, v10, v22
    v_add_f32 v11, v11, v23
    v_add_f32 v10, v10, v24
    v_add_f32 v11, v11, v25
    v_add_f32 v10, v10, v26
    v_add_f32 v11, v11, v27
    v_add_f32 v10, v10, v28
    v_add_f32 v11, v11, v29
    v_add_f32 v10, v10, v30
    v_add_f32 v11, v11, v31
    v_add_f32 v10, v10, v32
    v_add_f32 v11, v11, v33
    v_add_f32 v10, v10, v34
    v_add_f32 v11, v11, v35
    v_add_f32 v10, v10, v36
    v_add_f32 v11, v11, v37
    v_add_f32 v10, v10, v38
    v_add_f32 v11, v11, v39
    v_add_f32 v10, v10, v40
    v_add_f32 v11, v11, v41
    v_cvt_pk_bf16_f32 v10, v10, v10
    v_lshlrev_b32 v10, 16, v10
    v_cvt_pk_bf16_f32 v11, v11, v11
    v_lshlrev_b32 v11, 16, v11
    s_waitcnt vmcnt(0)
    v_lshlrev_b32 v50, 16, v50
    v_add_f32 v50, v50, v10
    v_cvt_pk_bf16_f32 v50, v50, v50
    v_lshlrev_b32 v50, 16, v50
    v_add_f32 v50, v50, v11
    v_cvt_pk_bf16_f32 v50, v50, v50
    buffer_store_short v50, v6, s[24:27], 0 offen
final_end:
    s_endpgm
.section .rodata,"a"
.p2align 6
.amdhsa_kernel proj_kernel
  .amdhsa_next_free_vgpr 128
  .amdhsa_next_free_sgpr 96
  .amdhsa_accum_offset 128
  .amdhsa_group_segment_fixed_size 0
  .amdhsa_kernarg_size 96
  .amdhsa_user_sgpr_count 2
  .amdhsa_user_sgpr_kernarg_segment_ptr 1
  .amdhsa_system_sgpr_workgroup_id_x 1
.end_amdhsa_kernel
.p2align 6
.amdhsa_kernel attn_kernel
  .amdhsa_next_free_vgpr 128
  .amdhsa_next_free_sgpr 96
  .amdhsa_accum_offset 128
  .amdhsa_group_segment_fixed_size 0
  .amdhsa_kernarg_size 96
  .amdhsa_user_sgpr_count 2
  .amdhsa_user_sgpr_kernarg_segment_ptr 1
  .amdhsa_system_sgpr_workgroup_id_x 1
.end_amdhsa_kernel
.p2align 6
.amdhsa_kernel outp_kernel
  .amdhsa_next_free_vgpr 128
  .amdhsa_next_free_sgpr 96
  .amdhsa_accum_offset 128
  .amdhsa_group_segment_fixed_size 0
  .amdhsa_kernarg_size 96
  .amdhsa_user_sgpr_count 2
  .amdhsa_user_sgpr_kernarg_segment_ptr 1
  .amdhsa_system_sgpr_workgroup_id_x 1
.end_amdhsa_kernel
.p2align 6
.amdhsa_kernel final_kernel
  .amdhsa_next_free_vgpr 128
  .amdhsa_next_free_sgpr 96
  .amdhsa_accum_offset 128
  .amdhsa_group_segment_fixed_size 0
  .amdhsa_kernarg_size 96
  .amdhsa_user_sgpr_count 2
  .amdhsa_user_sgpr_kernarg_segment_ptr 1
  .amdhsa_system_sgpr_workgroup_id_x 1
.end_amdhsa_kernel
```
